```python
import torch

def _softmax(x, axis=-1):
    return torch.softmax(x, dim=axis)
def _gelu(x):
    return torch.nn.functional.gelu(x, approximate="tanh")
def _silu(x):
    return torch.nn.functional.silu(x)
def _sigmoid(x):
    return torch.sigmoid(x)
def _layernorm(x, axis=-1, eps=1e-5):
    m = x.mean(dim=axis, keepdim=True)
    v = x.var(dim=axis, keepdim=True, unbiased=False)
    return (x - m) / torch.sqrt(v + eps)
def _scatter_add(tgt, idx, src, axis=0):
    return tgt.clone().index_add_(axis, idx, src)
def _segment_sum(src, seg, n):
    out = torch.zeros((n,) + src.shape[1:], dtype=src.dtype)
    return out.index_add_(0, seg, src)
def _pad(x, pw):
    flat = tuple(v for pair in reversed(pw) for v in pair)
    return torch.nn.functional.pad(x, flat)

kernel_name = 'concat_heads__sliding_block_cached__gqa_block_cached__decode'

def setup_inputs():

    _w = (lambda a: (lambda t: t.to(torch.bfloat16) if t.is_floating_point() else t)(torch.as_tensor(a)))
    def _A_setup():
        B, Sq, D = 1, 1, 576
        Hq, Hkv, Sk, Dh = 32, 16, 32768, 128
        assert Hq % Hkv == 0, (Hq, Hkv)
        return {
            "x": _w((lambda *s: torch.randn(*s, dtype=torch.bfloat16) * 0.8)(B, Sq, D)),
            "k_cache": _w((lambda *s: torch.randn(*s, dtype=torch.bfloat16) * 1.6)(B, Hkv, Sk, Dh)),
            "v_cache": _w((lambda *s: torch.randn(*s, dtype=torch.bfloat16) * 0.2)(B, Hkv, Sk, Dh)),
            "wq": _w((lambda *s: torch.randn(*s, dtype=torch.bfloat16) * 1.6)(D, Hq * Dh) * (D ** -0.5)),
            "wo": _w((lambda *s: torch.randn(*s, dtype=torch.bfloat16) * 0.2)(Hq * Dh, D) * ((Hq * Dh) ** -0.5)),
        }
    _A_in = _A_setup()

    def _B_setup():
        B, Sq, D = 1, 1, 576
        Hq, Hkv, Sk, Dh = 32, 16, 32768, 128
        assert Hq % Hkv == 0, (Hq, Hkv)
        return {
            "x": _w((lambda *s: torch.randn(*s, dtype=torch.bfloat16) * 0.8)(B, Sq, D)),
            "k_cache": _w((lambda *s: torch.randn(*s, dtype=torch.bfloat16) * 1.6)(B, Hkv, Sk, Dh)),
            "v_cache": _w((lambda *s: torch.randn(*s, dtype=torch.bfloat16) * 0.2)(B, Hkv, Sk, Dh)),
            "wq": _w((lambda *s: torch.randn(*s, dtype=torch.bfloat16) * 1.6)(D, Hq * Dh) * (D ** -0.5)),
            "wo": _w((lambda *s: torch.randn(*s, dtype=torch.bfloat16) * 0.2)(Hq * Dh, D) * ((Hq * Dh) ** -0.5)),
        }
    _B_in = _B_setup()

    return {
        "A_x": _A_in["x"],
        "A_k_cache": _A_in["k_cache"],
        "A_v_cache": _A_in["v_cache"],
        "A_wq": _A_in["wq"],
        "A_wo": _A_in["wo"],
        "B_x": _B_in["x"],
        "B_k_cache": _B_in["k_cache"],
        "B_v_cache": _B_in["v_cache"],
        "B_wq": _B_in["wq"],
        "B_wo": _B_in["wo"],
    }

def reference(A_x, A_k_cache, A_v_cache, A_wq, A_wo, B_x, B_k_cache, B_v_cache, B_wq, B_wo):
    def _A_ref(x, k_cache, v_cache, wq, wo):
        B, Sq, D = x.shape
        Hq, Dh = 32, 128
        Hkv, Sk = k_cache.shape[1], k_cache.shape[2]
        W = min(4096, max(256, Sk // 4))
        rep = Hq // Hkv
        q = (lambda x, *d: x.permute(*d))((x @ wq).reshape(B, Sq, Hq, Dh), 0, 2, 1, 3)
        k = (lambda x, n, axis: torch.repeat_interleave(x, n, dim=axis))(k_cache[:, :, Sk - W:, :], rep, axis=1)
        v = (lambda x, n, axis: torch.repeat_interleave(x, n, dim=axis))(v_cache[:, :, Sk - W:, :], rep, axis=1)
        scores = torch.einsum("bhqd,bhkd->bhqk", q, k) * (Dh ** -0.5)
        p = _softmax(scores, axis=-1)
        o = torch.einsum("bhqk,bhkd->bhqd", p, v)
        return (lambda x, *d: x.permute(*d))(o, 0, 2, 1, 3).reshape(B, Sq, Hq * Dh) @ wo

    def _B_ref(x, k_cache, v_cache, wq, wo):
        B, Sq, D = x.shape
        Hq, Dh = 32, 128
        Hkv = k_cache.shape[1]
        rep = Hq // Hkv
        q = (lambda x, *d: x.permute(*d))((x @ wq).reshape(B, Sq, Hq, Dh), 0, 2, 1, 3)
        k = (lambda x, n, axis: torch.repeat_interleave(x, n, dim=axis))(k_cache, rep, axis=1)
        v = (lambda x, n, axis: torch.repeat_interleave(x, n, dim=axis))(v_cache, rep, axis=1)
        scores = torch.einsum("bhqd,bhkd->bhqk", q, k) * (Dh ** -0.5)
        p = _softmax(scores, axis=-1)
        o = torch.einsum("bhqk,bhkd->bhqd", p, v)
        return (lambda x, *d: x.permute(*d))(o, 0, 2, 1, 3).reshape(B, Sq, Hq * Dh) @ wo

    a = _A_ref(A_x, A_k_cache, A_v_cache, A_wq, A_wo)
    b = _B_ref(B_x, B_k_cache, B_v_cache, B_wq, B_wo)
    return torch.concatenate([a, b], axis=-1)
```

```asm
; @launch grid=(256,1,1) block=(448,1,1) lds=158784
.amdgcn_target "amdgcn-amd-amdhsa--gfx950"
.text
.globl concat_heads__sliding_block_cached__gqa_block_cached__decode_kernel
.p2align 8
.type concat_heads__sliding_block_cached__gqa_block_cached__decode_kernel,@function
concat_heads__sliding_block_cached__gqa_block_cached__decode_kernel:
    s_cmp_ge_u32 s2, 256
    s_cbranch_scc1 L_end
    s_load_dwordx16 s[4:19], s[0:1], 0
    s_load_dwordx8 s[20:27], s[0:1], 64
    s_load_dwordx2 s[28:29], s[0:1], 96
    s_getpc_b64 s[66:67]
L_pc:
    v_lshlrev_b32 v234, 5, v0
    v_min_u32 v234, L_codeend-L_pc-4, v234
    global_load_dword v235, v234, s[66:67]
    v_lshrrev_b32 v12, 6, v0
    v_and_b32 v0, 63, v0
    v_readfirstlane_b32 s54, v12
    v_lshrrev_b32 v1, 4, v0
    v_and_b32 v2, 15, v0
    s_lshr_b32 s52, s2, 4
    s_and_b32 s53, s2, 15
    s_nop 1
    s_cmp_eq_u32 s54, 2
    s_cbranch_scc0 L_others
L_service:
    v_lshrrev_b32 v18, 3, v0
    v_and_b32 v19, 7, v0
    s_and_b32 s33, s53, 1
    s_mul_i32 s33, s33, 288
    v_mul_u32_u24 v40, 36, v18
    v_add_u32 v40, s33, v40
    v_lshlrev_b32 v41, 13, v40
    v_lshlrev_b32 v40, 1, v40
    v_lshl_add_u32 v41, v19, 4, v41
    s_lshl_b32 s33, s2, 6
    s_and_b32 s57, s33, 0x180
    s_lshr_b32 s33, s33, 1
    s_and_b32 s33, s33, 0x1e00
    s_add_u32 s57, s57, s33
    s_mov_b32 s42, 4718592
    s_mov_b32 s43, 0x20000
    s_mov_b32 s46, 1152
    s_mov_b32 s47, 0x20000
    s_cmp_ge_u32 s53, 8
    s_waitcnt lgkmcnt(0)
    s_cselect_b32 s40, s20, s10
    s_cselect_b32 s41, s21, s11
    s_cselect_b32 s44, s14, s4
    s_cselect_b32 s45, s15, s5
    buffer_load_dwordx4 v[60:63], v41, s[40:43], s57 offen nt
    s_addk_i32 s57, 0x2000
    buffer_load_dwordx4 v[64:67], v41, s[40:43], s57 offen nt
    s_addk_i32 s57, 0x2000
    buffer_load_dwordx4 v[68:71], v41, s[40:43], s57 offen nt
    s_addk_i32 s57, 0x2000
    buffer_load_dwordx4 v[72:75], v41, s[40:43], s57 offen nt
    s_addk_i32 s57, 0x2000
    buffer_load_dwordx4 v[20:23], v40, s[44:47], 0 offen offset:0
    buffer_load_dwordx4 v[24:27], v40, s[44:47], 0 offen offset:16
    buffer_load_dwordx4 v[28:31], v40, s[44:47], 0 offen offset:32
    buffer_load_dwordx4 v[32:35], v40, s[44:47], 0 offen offset:48
    buffer_load_dwordx2 v[36:37], v40, s[44:47], 0 offen offset:64
    buffer_load_dwordx4 v[76:79], v41, s[40:43], s57 offen nt
    s_addk_i32 s57, 0x2000
    buffer_load_dwordx4 v[80:83], v41, s[40:43], s57 offen nt
    s_addk_i32 s57, 0x2000
    buffer_load_dwordx4 v[84:87], v41, s[40:43], s57 offen nt
    s_addk_i32 s57, 0x2000
    buffer_load_dwordx4 v[88:91], v41, s[40:43], s57 offen nt
    s_addk_i32 s57, 0x2000
    buffer_load_dwordx4 v[92:95], v41, s[40:43], s57 offen nt
    s_addk_i32 s57, 0x2000
    buffer_load_dwordx4 v[96:99], v41, s[40:43], s57 offen nt
    s_addk_i32 s57, 0x2000
    buffer_load_dwordx4 v[100:103], v41, s[40:43], s57 offen nt
    s_addk_i32 s57, 0x2000
    buffer_load_dwordx4 v[104:107], v41, s[40:43], s57 offen nt
    s_addk_i32 s57, 0x2000
    buffer_load_dwordx4 v[108:111], v41, s[40:43], s57 offen nt
    s_addk_i32 s57, 0x2000
    buffer_load_dwordx4 v[112:115], v41, s[40:43], s57 offen nt
    s_addk_i32 s57, 0x2000
    buffer_load_dwordx4 v[116:119], v41, s[40:43], s57 offen nt
    s_addk_i32 s57, 0x2000
    buffer_load_dwordx4 v[120:123], v41, s[40:43], s57 offen nt
    s_addk_i32 s57, 0x2000
    buffer_load_dwordx4 v[124:127], v41, s[40:43], s57 offen nt
    s_addk_i32 s57, 0x2000
    buffer_load_dwordx4 v[128:131], v41, s[40:43], s57 offen nt
    s_addk_i32 s57, 0x2000
    buffer_load_dwordx4 v[132:135], v41, s[40:43], s57 offen nt
    s_addk_i32 s57, 0x2000
    buffer_load_dwordx4 v[136:139], v41, s[40:43], s57 offen nt
    s_addk_i32 s57, 0x2000
    buffer_load_dwordx4 v[140:143], v41, s[40:43], s57 offen nt
    s_addk_i32 s57, 0x2000
    buffer_load_dwordx4 v[144:147], v41, s[40:43], s57 offen nt
    s_addk_i32 s57, 0x2000
    buffer_load_dwordx4 v[148:151], v41, s[40:43], s57 offen nt
    s_addk_i32 s57, 0x2000
    buffer_load_dwordx4 v[152:155], v41, s[40:43], s57 offen nt
    s_addk_i32 s57, 0x2000
    buffer_load_dwordx4 v[156:159], v41, s[40:43], s57 offen nt
    s_addk_i32 s57, 0x2000
    buffer_load_dwordx4 v[160:163], v41, s[40:43], s57 offen nt
    s_addk_i32 s57, 0x2000
    buffer_load_dwordx4 v[164:167], v41, s[40:43], s57 offen nt
    s_addk_i32 s57, 0x2000
    buffer_load_dwordx4 v[168:171], v41, s[40:43], s57 offen nt
    s_addk_i32 s57, 0x2000
    buffer_load_dwordx4 v[172:175], v41, s[40:43], s57 offen nt
    s_addk_i32 s57, 0x2000
    buffer_load_dwordx4 v[176:179], v41, s[40:43], s57 offen nt
    s_addk_i32 s57, 0x2000
    buffer_load_dwordx4 v[180:183], v41, s[40:43], s57 offen nt
    s_addk_i32 s57, 0x2000
    buffer_load_dwordx4 v[184:187], v41, s[40:43], s57 offen nt
    s_addk_i32 s57, 0x2000
    buffer_load_dwordx4 v[188:191], v41, s[40:43], s57 offen nt
    s_addk_i32 s57, 0x2000
    buffer_load_dwordx4 v[192:195], v41, s[40:43], s57 offen nt
    s_addk_i32 s57, 0x2000
    buffer_load_dwordx4 v[196:199], v41, s[40:43], s57 offen nt
    s_addk_i32 s57, 0x2000
    buffer_load_dwordx4 v[200:203], v41, s[40:43], s57 offen nt
    v_mov_b32 v226, 158720
    v_mov_b32 v12, 0
    s_barrier
    s_setprio 3
    s_load_dword s30, s[28:29], 0
    s_mov_b32 s36, s28
    s_mov_b32 s37, s29
    s_mov_b32 s38, 0x200000
    s_mov_b32 s39, 0x20000
    s_lshr_b32 s33, s2, 4
    s_mul_i32 s33, s33, 256
    s_add_u32 s33, s33, 1114112
    s_and_b32 s34, s53, 15
    s_cmp_eq_u32 s34, 0
    s_cselect_b32 s33, s33, 0x200000
    v_mov_b32 v42, s33
    s_mov_b64 exec, 1
    buffer_store_dword v12, v42, s[36:39], 0 offen sc1
    s_mov_b64 exec, -1
    v_and_b32 v12, 1, v0
    v_bfe_u32 v13, v0, 1, 2
    v_mov_b32 v14, 0x0c0c0100
    v_mov_b32 v15, 0x01000c0c
    v_cmp_eq_u32 vcc, 1, v12
    v_mov_b32 v16, 0x0c0c0302
    v_mov_b32 v17, 0x03020c0c
    v_cndmask_b32 v14, v14, v15, vcc
    v_cndmask_b32 v16, v16, v17, vcc
    v_mov_b32 v15, 0x0c0c0c0c
    v_cmp_eq_u32 vcc, 0, v13
    s_nop 1
    v_cndmask_b32 v4, v15, v14, vcc
    v_cndmask_b32 v8, v15, v16, vcc
    v_cmp_eq_u32 vcc, 1, v13
    s_nop 1
    v_cndmask_b32 v5, v15, v14, vcc
    v_cndmask_b32 v9, v15, v16, vcc
    v_cmp_eq_u32 vcc, 2, v13
    s_nop 1
    v_cndmask_b32 v6, v15, v14, vcc
    v_cndmask_b32 v10, v15, v16, vcc
    v_cmp_eq_u32 vcc, 3, v13
    s_nop 1
    v_cndmask_b32 v7, v15, v14, vcc
    v_cndmask_b32 v11, v15, v16, vcc
    s_mov_b32 s68, 0x07060500
    v_and_b32 v19, 7, v0
    v_lshlrev_b32 v38, 4, v19
    v_lshl_add_u32 v38, v1, 7, v38
    s_lshl_b32 s33, s2, 8
    s_add_u32 s33, s33, 65536
    v_add_u32 v38, s33, v38
    s_lshl_b32 s33, s52, 12
    s_add_u32 s33, s33, 65536
    v_lshlrev_b32 v39, 4, v0
    v_add_u32 v39, s33, v39
    v_and_b32 v12, 1, v1
    v_lshrrev_b32 v13, 1, v1
    v_lshl_add_u32 v12, v12, 1, v13
    v_lshlrev_b32 v12, 7, v12
    v_lshl_add_u32 v12, v19, 4, v12
    v_bfe_u32 v13, v0, 3, 1
    v_lshl_add_u32 v12, v13, 3, v12
    v_add_u32 v40, 131072, v12
    s_waitcnt vmcnt(32)
    v_perm_b32 v52, v20, v20, v4
    v_perm_b32 v53, v20, v20, v5
    v_perm_b32 v54, v20, v20, v6
    v_perm_b32 v55, v20, v20, v7
    v_perm_b32 v56, v20, v20, v8
    v_perm_b32 v57, v20, v20, v9
    v_perm_b32 v58, v20, v20, v10
    v_perm_b32 v59, v20, v20, v11
    s_nop 0
    v_mfma_f32_16x16x32_bf16 v[44:47], v[52:55], v[60:63], 0
    v_perm_b32 v52, v21, v21, v4
    v_perm_b32 v53, v21, v21, v5
    v_perm_b32 v54, v21, v21, v6
    v_perm_b32 v55, v21, v21, v7
    s_nop 0
    v_mfma_f32_16x16x32_bf16 v[44:47], v[56:59], v[64:67], v[44:47]
    v_perm_b32 v56, v21, v21, v8
    v_perm_b32 v57, v21, v21, v9
    v_perm_b32 v58, v21, v21, v10
    v_perm_b32 v59, v21, v21, v11
    s_nop 0
    v_mfma_f32_16x16x32_bf16 v[44:47], v[52:55], v[68:71], v[44:47]
    v_perm_b32 v52, v22, v22, v4
    v_perm_b32 v53, v22, v22, v5
    v_perm_b32 v54, v22, v22, v6
    v_perm_b32 v55, v22, v22, v7
    s_nop 0
    v_mfma_f32_16x16x32_bf16 v[44:47], v[56:59], v[72:75], v[44:47]
    v_perm_b32 v56, v22, v22, v8
    v_perm_b32 v57, v22, v22, v9
    v_perm_b32 v58, v22, v22, v10
    v_perm_b32 v59, v22, v22, v11
    s_waitcnt vmcnt(31)
    v_mfma_f32_16x16x32_bf16 v[44:47], v[52:55], v[76:79], v[44:47]
    v_perm_b32 v52, v23, v23, v4
    v_perm_b32 v53, v23, v23, v5
    v_perm_b32 v54, v23, v23, v6
    v_perm_b32 v55, v23, v23, v7
    s_waitcnt vmcnt(30)
    v_mfma_f32_16x16x32_bf16 v[44:47], v[56:59], v[80:83], v[44:47]
    v_perm_b32 v56, v23, v23, v8
    v_perm_b32 v57, v23, v23, v9
    v_perm_b32 v58, v23, v23, v10
    v_perm_b32 v59, v23, v23, v11
    s_waitcnt vmcnt(29)
    v_mfma_f32_16x16x32_bf16 v[44:47], v[52:55], v[84:87], v[44:47]
    v_perm_b32 v52, v24, v24, v4
    v_perm_b32 v53, v24, v24, v5
    v_perm_b32 v54, v24, v24, v6
    v_perm_b32 v55, v24, v24, v7
    s_waitcnt vmcnt(28)
    v_mfma_f32_16x16x32_bf16 v[44:47], v[56:59], v[88:91], v[44:47]
    v_perm_b32 v56, v24, v24, v8
    v_perm_b32 v57, v24, v24, v9
    v_perm_b32 v58, v24, v24, v10
    v_perm_b32 v59, v24, v24, v11
    s_waitcnt vmcnt(27)
    v_mfma_f32_16x16x32_bf16 v[44:47], v[52:55], v[92:95], v[44:47]
    v_perm_b32 v52, v25, v25, v4
    v_perm_b32 v53, v25, v25, v5
    v_perm_b32 v54, v25, v25, v6
    v_perm_b32 v55, v25, v25, v7
    s_waitcnt vmcnt(26)
    v_mfma_f32_16x16x32_bf16 v[44:47], v[56:59], v[96:99], v[44:47]
    v_perm_b32 v56, v25, v25, v8
    v_perm_b32 v57, v25, v25, v9
    v_perm_b32 v58, v25, v25, v10
    v_perm_b32 v59, v25, v25, v11
    s_waitcnt vmcnt(25)
    v_mfma_f32_16x16x32_bf16 v[44:47], v[52:55], v[100:103], v[44:47]
    v_perm_b32 v52, v26, v26, v4
    v_perm_b32 v53, v26, v26, v5
    v_perm_b32 v54, v26, v26, v6
    v_perm_b32 v55, v26, v26, v7
    s_waitcnt vmcnt(24)
    v_mfma_f32_16x16x32_bf16 v[44:47], v[56:59], v[104:107], v[44:47]
    v_perm_b32 v56, v26, v26, v8
    v_perm_b32 v57, v26, v26, v9
    v_perm_b32 v58, v26, v26, v10
    v_perm_b32 v59, v26, v26, v11
    s_waitcnt vmcnt(23)
    v_mfma_f32_16x16x32_bf16 v[44:47], v[52:55], v[108:111], v[44:47]
    v_perm_b32 v52, v27, v27, v4
    v_perm_b32 v53, v27, v27, v5
    v_perm_b32 v54, v27, v27, v6
    v_perm_b32 v55, v27, v27, v7
    s_waitcnt vmcnt(22)
    v_mfma_f32_16x16x32_bf16 v[44:47], v[56:59], v[112:115], v[44:47]
    v_perm_b32 v56, v27, v27, v8
    v_perm_b32 v57, v27, v27, v9
    v_perm_b32 v58, v27, v27, v10
    v_perm_b32 v59, v27, v27, v11
    s_waitcnt vmcnt(21)
    v_mfma_f32_16x16x32_bf16 v[44:47], v[52:55], v[116:119], v[44:47]
    v_perm_b32 v52, v28, v28, v4
    v_perm_b32 v53, v28, v28, v5
    v_perm_b32 v54, v28, v28, v6
    v_perm_b32 v55, v28, v28, v7
    s_waitcnt vmcnt(20)
    v_mfma_f32_16x16x32_bf16 v[44:47], v[56:59], v[120:123], v[44:47]
    v_perm_b32 v56, v28, v28, v8
    v_perm_b32 v57, v28, v28, v9
    v_perm_b32 v58, v28, v28, v10
    v_perm_b32 v59, v28, v28, v11
    s_waitcnt vmcnt(19)
    v_mfma_f32_16x16x32_bf16 v[44:47], v[52:55], v[124:127], v[44:47]
    v_perm_b32 v52, v29, v29, v4
    v_perm_b32 v53, v29, v29, v5
    v_perm_b32 v54, v29, v29, v6
    v_perm_b32 v55, v29, v29, v7
    s_waitcnt vmcnt(18)
    v_mfma_f32_16x16x32_bf16 v[44:47], v[56:59], v[128:131], v[44:47]
    v_perm_b32 v56, v29, v29, v8
    v_perm_b32 v57, v29, v29, v9
    v_perm_b32 v58, v29, v29, v10
    v_perm_b32 v59, v29, v29, v11
    s_waitcnt vmcnt(17)
    v_mfma_f32_16x16x32_bf16 v[44:47], v[52:55], v[132:135], v[44:47]
    v_perm_b32 v52, v30, v30, v4
    v_perm_b32 v53, v30, v30, v5
    v_perm_b32 v54, v30, v30, v6
    v_perm_b32 v55, v30, v30, v7
    s_waitcnt vmcnt(16)
    v_mfma_f32_16x16x32_bf16 v[44:47], v[56:59], v[136:139], v[44:47]
    v_perm_b32 v56, v30, v30, v8
    v_perm_b32 v57, v30, v30, v9
    v_perm_b32 v58, v30, v30, v10
    v_perm_b32 v59, v30, v30, v11
    s_waitcnt vmcnt(15)
    v_mfma_f32_16x16x32_bf16 v[44:47], v[52:55], v[140:143], v[44:47]
    v_perm_b32 v52, v31, v31, v4
    v_perm_b32 v53, v31, v31, v5
    v_perm_b32 v54, v31, v31, v6
    v_perm_b32 v55, v31, v31, v7
    s_waitcnt vmcnt(14)
    v_mfma_f32_16x16x32_bf16 v[44:47], v[56:59], v[144:147], v[44:47]
    v_perm_b32 v56, v31, v31, v8
    v_perm_b32 v57, v31, v31, v9
    v_perm_b32 v58, v31, v31, v10
    v_perm_b32 v59, v31, v31, v11
    s_waitcnt vmcnt(13)
    v_mfma_f32_16x16x32_bf16 v[44:47], v[52:55], v[148:151], v[44:47]
    v_perm_b32 v52, v32, v32, v4
    v_perm_b32 v53, v32, v32, v5
    v_perm_b32 v54, v32, v32, v6
    v_perm_b32 v55, v32, v32, v7
    s_waitcnt vmcnt(12)
    v_mfma_f32_16x16x32_bf16 v[44:47], v[56:59], v[152:155], v[44:47]
    v_perm_b32 v56, v32, v32, v8
    v_perm_b32 v57, v32, v32, v9
    v_perm_b32 v58, v32, v32, v10
    v_perm_b32 v59, v32, v32, v11
    s_waitcnt vmcnt(11)
    v_mfma_f32_16x16x32_bf16 v[44:47], v[52:55], v[156:159], v[44:47]
    v_perm_b32 v52, v33, v33, v4
    v_perm_b32 v53, v33, v33, v5
    v_perm_b32 v54, v33, v33, v6
    v_perm_b32 v55, v33, v33, v7
    s_waitcnt vmcnt(10)
    v_mfma_f32_16x16x32_bf16 v[44:47], v[56:59], v[160:163], v[44:47]
    v_perm_b32 v56, v33, v33, v8
    v_perm_b32 v57, v33, v33, v9
    v_perm_b32 v58, v33, v33, v10
    v_perm_b32 v59, v33, v33, v11
    s_waitcnt vmcnt(9)
    v_mfma_f32_16x16x32_bf16 v[44:47], v[52:55], v[164:167], v[44:47]
    v_perm_b32 v52, v34, v34, v4
    v_perm_b32 v53, v34, v34, v5
    v_perm_b32 v54, v34, v34, v6
    v_perm_b32 v55, v34, v34, v7
    s_waitcnt vmcnt(8)
    v_mfma_f32_16x16x32_bf16 v[44:47], v[56:59], v[168:171], v[44:47]
    v_perm_b32 v56, v34, v34, v8
    v_perm_b32 v57, v34, v34, v9
    v_perm_b32 v58, v34, v34, v10
    v_perm_b32 v59, v34, v34, v11
    s_waitcnt vmcnt(7)
    v_mfma_f32_16x16x32_bf16 v[44:47], v[52:55], v[172:175], v[44:47]
    v_perm_b32 v52, v35, v35, v4
    v_perm_b32 v53, v35, v35, v5
    v_perm_b32 v54, v35, v35, v6
    v_perm_b32 v55, v35, v35, v7
    s_waitcnt vmcnt(6)
    v_mfma_f32_16x16x32_bf16 v[44:47], v[56:59], v[176:179], v[44:47]
    v_perm_b32 v56, v35, v35, v8
    v_perm_b32 v57, v35, v35, v9
    v_perm_b32 v58, v35, v35, v10
    v_perm_b32 v59, v35, v35, v11
    s_waitcnt vmcnt(5)
    v_mfma_f32_16x16x32_bf16 v[44:47], v[52:55], v[180:183], v[44:47]
    v_perm_b32 v52, v36, v36, v4
    v_perm_b32 v53, v36, v36, v5
    v_perm_b32 v54, v36, v36, v6
    v_perm_b32 v55, v36, v36, v7
    s_waitcnt vmcnt(4)
    v_mfma_f32_16x16x32_bf16 v[44:47], v[56:59], v[184:187], v[44:47]
    v_perm_b32 v56, v36, v36, v8
    v_perm_b32 v57, v36, v36, v9
    v_perm_b32 v58, v36, v36, v10
    v_perm_b32 v59, v36, v36, v11
    s_waitcnt vmcnt(3)
    v_mfma_f32_16x16x32_bf16 v[44:47], v[52:55], v[188:191], v[44:47]
    v_perm_b32 v52, v37, v37, v4
    v_perm_b32 v53, v37, v37, v5
    v_perm_b32 v54, v37, v37, v6
    v_perm_b32 v55, v37, v37, v7
    s_waitcnt vmcnt(2)
    v_mfma_f32_16x16x32_bf16 v[44:47], v[56:59], v[192:195], v[44:47]
    v_perm_b32 v56, v37, v37, v8
    v_perm_b32 v57, v37, v37, v9
    v_perm_b32 v58, v37, v37, v10
    v_perm_b32 v59, v37, v37, v11
    s_waitcnt vmcnt(1)
    v_mfma_f32_16x16x32_bf16 v[44:47], v[52:55], v[196:199], v[44:47]
    s_waitcnt vmcnt(0)
    s_nop 0
    v_mfma_f32_16x16x32_bf16 v[44:47], v[56:59], v[200:203], v[44:47]
    s_waitcnt lgkmcnt(0)
    s_add_u32 s30, s30, 1
    s_and_b32 s30, s30, 0xff
    v_mov_b32 v228, s30
    s_nop 3
    v_permlane32_swap_b32 v44, v48
    v_permlane32_swap_b32 v45, v49
    v_permlane32_swap_b32 v46, v50
    v_permlane32_swap_b32 v47, v51
    s_nop 1
    v_add_f32_dpp v44, v48, v44 row_ror:8 row_mask:0xf bank_mask:0xf
    v_add_f32_dpp v45, v49, v45 row_ror:8 row_mask:0xf bank_mask:0xf
    v_add_f32_dpp v46, v50, v46 row_ror:8 row_mask:0xf bank_mask:0xf
    v_add_f32_dpp v47, v51, v47 row_ror:8 row_mask:0xf bank_mask:0xf
    v_perm_b32 v52, v44, v228, s68
    v_perm_b32 v53, v45, v228, s68
    v_perm_b32 v54, v46, v228, s68
    v_perm_b32 v55, v47, v228, s68
    s_mov_b64 exec, 0x00ff00ff
    buffer_store_dwordx4 v[52:55], v38, s[36:39], 0 offen sc1
    s_mov_b64 exec, -1
    s_waitcnt vmcnt(0)
    s_mov_b32 s60, 0
    s_mov_b64 s[50:51], -1
    s_mov_b64 exec, -1
L_pqa:
    buffer_load_dwordx4 v[188:191], v39, s[36:39], 0 offen offset:0 sc1
    buffer_load_dwordx4 v[192:195], v39, s[36:39], 0 offen offset:1024 sc1
    buffer_load_dwordx4 v[196:199], v39, s[36:39], 0 offen offset:2048 sc1
    buffer_load_dwordx4 v[200:203], v39, s[36:39], 0 offen offset:3072 sc1
    s_add_u32 s60, s60, 1
    s_mov_b32 s33, 1
    s_cmp_ge_u32 s60, 16384
    s_cbranch_scc1 L_fail
    s_waitcnt vmcnt(3)
    v_cmpx_eq_u32_sdwa vcc, v188, v228 src0_sel:BYTE_0 src1_sel:DWORD
    v_cmpx_eq_u32_sdwa vcc, v189, v228 src0_sel:BYTE_0 src1_sel:DWORD
    v_cmpx_eq_u32_sdwa vcc, v190, v228 src0_sel:BYTE_0 src1_sel:DWORD
    v_cmpx_eq_u32_sdwa vcc, v191, v228 src0_sel:BYTE_0 src1_sel:DWORD
    s_waitcnt vmcnt(2)
    v_cmpx_eq_u32_sdwa vcc, v192, v228 src0_sel:BYTE_0 src1_sel:DWORD
    v_cmpx_eq_u32_sdwa vcc, v193, v228 src0_sel:BYTE_0 src1_sel:DWORD
    v_cmpx_eq_u32_sdwa vcc, v194, v228 src0_sel:BYTE_0 src1_sel:DWORD
    v_cmpx_eq_u32_sdwa vcc, v195, v228 src0_sel:BYTE_0 src1_sel:DWORD
    s_waitcnt vmcnt(1)
    v_cmpx_eq_u32_sdwa vcc, v196, v228 src0_sel:BYTE_0 src1_sel:DWORD
    v_cmpx_eq_u32_sdwa vcc, v197, v228 src0_sel:BYTE_0 src1_sel:DWORD
    v_cmpx_eq_u32_sdwa vcc, v198, v228 src0_sel:BYTE_0 src1_sel:DWORD
    v_cmpx_eq_u32_sdwa vcc, v199, v228 src0_sel:BYTE_0 src1_sel:DWORD
    s_waitcnt vmcnt(0)
    v_cmpx_eq_u32_sdwa vcc, v200, v228 src0_sel:BYTE_0 src1_sel:DWORD
    v_cmpx_eq_u32_sdwa vcc, v201, v228 src0_sel:BYTE_0 src1_sel:DWORD
    v_cmpx_eq_u32_sdwa vcc, v202, v228 src0_sel:BYTE_0 src1_sel:DWORD
    v_cmpx_eq_u32_sdwa vcc, v203, v228 src0_sel:BYTE_0 src1_sel:DWORD
    s_nop 3
    s_andn2_b64 s[50:51], s[50:51], exec
    s_mov_b64 exec, s[50:51]
    s_cbranch_scc1 L_pqa
    s_mov_b64 exec, -1
    v_permlane16_swap_b32 v188, v192
    v_permlane16_swap_b32 v189, v193
    v_permlane16_swap_b32 v190, v194
    v_permlane16_swap_b32 v191, v195
    v_add_f32 v188, v188, v192
    v_add_f32 v189, v189, v193
    v_add_f32 v190, v190, v194
    v_add_f32 v191, v191, v195
    v_cvt_pk_bf16_f32 v188, v188, v189
    v_cvt_pk_bf16_f32 v189, v190, v191
    ds_write_b64 v40, v[188:189] offset:0
    v_permlane16_swap_b32 v196, v200
    v_permlane16_swap_b32 v197, v201
    v_permlane16_swap_b32 v198, v202
    v_permlane16_swap_b32 v199, v203
    v_add_f32 v196, v196, v200
    v_add_f32 v197, v197, v201
    v_add_f32 v198, v198, v202
    v_add_f32 v199, v199, v203
    v_cvt_pk_bf16_f32 v196, v196, v197
    v_cvt_pk_bf16_f32 v197, v198, v199
    ds_write_b64 v40, v[196:197] offset:512
    ds_write_b32 v226, v228 offset:12
    v_mov_b32 v12, 1
    s_waitcnt lgkmcnt(0)
    ds_write_b32 v226, v12
    s_mov_b32 s56, 1
    s_branch L_tail
L_awave:
    s_barrier
    v_mov_b32 v226, 158720
    s_mov_b32 s56, 0
    s_mov_b32 s60, 0
    v_and_b32 v12, 1, v0
    v_bfe_u32 v13, v0, 1, 2
    v_mov_b32 v14, 0x0c0c0100
    v_mov_b32 v15, 0x01000c0c
    v_cmp_eq_u32 vcc, 1, v12
    v_mov_b32 v16, 0x0c0c0302
    v_mov_b32 v17, 0x03020c0c
    v_cndmask_b32 v14, v14, v15, vcc
    v_cndmask_b32 v16, v16, v17, vcc
    v_mov_b32 v15, 0x0c0c0c0c
    v_cmp_eq_u32 vcc, 0, v13
    s_nop 1
    v_cndmask_b32 v4, v15, v14, vcc
    v_cndmask_b32 v8, v15, v16, vcc
    v_cmp_eq_u32 vcc, 1, v13
    s_nop 1
    v_cndmask_b32 v5, v15, v14, vcc
    v_cndmask_b32 v9, v15, v16, vcc
    v_cmp_eq_u32 vcc, 2, v13
    s_nop 1
    v_cndmask_b32 v6, v15, v14, vcc
    v_cndmask_b32 v10, v15, v16, vcc
    v_cmp_eq_u32 vcc, 3, v13
    s_nop 1
    v_cndmask_b32 v7, v15, v14, vcc
    v_cndmask_b32 v11, v15, v16, vcc
    s_mov_b32 s68, 0x07060500
    s_waitcnt lgkmcnt(0)
    s_mov_b32 s36, s28
    s_mov_b32 s37, s29
    s_mov_b32 s38, 0x200000
    s_mov_b32 s39, 0x20000
    s_mov_b32 s42, 4718592
    s_mov_b32 s43, 0x20000
L_awq:
    ds_read_b32 v12, v226
    ds_read_b32 v228, v226 offset:12
    s_add_u32 s60, s60, 1
    s_cmp_ge_u32 s60, 1048576
    s_cbranch_scc1 L_end
    s_waitcnt lgkmcnt(0)
    v_readfirstlane_b32 s33, v12
    s_sleep 4
    s_cmp_eq_u32 s33, 0
    s_cbranch_scc1 L_awq
    s_waitcnt vmcnt(0)
L_tail:
    s_lshr_b32 s59, s53, 2
    s_and_b32 s58, s53, 3
    s_lshl_b32 s35, s52, 2
    s_add_u32 s35, s35, s59
    v_and_b32 v12, 1, v1
    v_lshrrev_b32 v13, 1, v1
    v_and_b32 v14, 7, v0
    v_bfe_u32 v15, v0, 3, 1
    v_and_b32 v18, 3, v0
    v_lshlrev_b32 v19, 4, v0
    v_lshlrev_b32 v16, 2, v12
    v_lshl_add_u32 v16, v13, 5, v16
    s_lshl_b32 s34, s35, 6
    v_add_u32 v16, s34, v16
    v_mul_u32_u24 v16, 1152, v16
    v_lshl_add_u32 v16, v2, 4, v16
    s_lshl_b32 s34, s58, 8
    v_add_u32 v223, s34, v16
    s_lshl_b32 s34, s35, 12
    s_add_u32 s34, s34, 262144
    v_lshrrev_b32 v16, 2, v0
    v_lshlrev_b32 v16, 8, v16
    v_lshl_add_u32 v16, v18, 4, v16
    v_add_u32 v218, s34, v16
    s_lshl_b32 s34, s52, 10
    s_add_u32 s34, s34, 131072
    v_add_u32 v219, s34, v19
    v_lshlrev_b32 v16, 4, v18
    v_add_u32 v217, s34, v16
    v_lshl_add_u32 v16, v15, 1, v13
    v_lshlrev_b32 v16, 12, v16
    v_lshl_add_u32 v17, v12, 3, v14
    v_lshl_add_u32 v16, v17, 4, v16
    s_lshl_b32 s33, s52, 14
    s_add_u32 s33, s33, 262144
    v_add_u32 v216, s33, v16
    s_lshl_b32 s33, s35, 6
    s_add_u32 s33, s33, 786432
    v_lshlrev_b32 v17, 4, v18
    v_add_u32 v17, s33, v17
    v_lshrrev_b32 v16, 2, v0
    v_lshl_add_u32 v16, v16, 12, v17
    s_lshl_b32 s34, s58, 15
    v_add_u32 v220, s34, v16
    v_bfe_u32 v16, v0, 2, 1
    v_lshl_add_u32 v16, v1, 1, v16
    v_lshl_add_u32 v16, v16, 12, v17
    v_add_u32 v221, 131072, v16
    s_sub_u32 s48, s2, 36
    s_cmp_eq_u32 s56, 1
    s_cselect_b32 s48, s2, s48
    s_cselect_b32 s32, 147456, 0
    s_cselect_b32 s49, 1152, 0
    s_and_b32 s33, s48, 63
    s_lshl_b32 s33, s33, 12
    s_add_u32 s33, s33, s32
    s_add_u32 s33, s33, 786432
    v_add_u32 v222, s33, v19
    v_add_u32 v224, 132096, v19
    v_lshlrev_b32 v16, 3, v0
    v_add_u32 v225, 140288, v16
    s_lshr_b32 s33, s48, 3
    s_lshl_b32 s33, s33, 7
    s_and_b32 s34, s48, 3
    s_bfe_u32 s57, s48, 0x10002
    s_cmp_ge_u32 s48, 32
    s_cbranch_scc0 L_ob
    s_and_b32 s34, s48, 1
    s_bfe_u32 s57, s48, 0x10001
L_ob:
    s_lshl_b32 s34, s34, 5
    s_lshl_b32 s57, s57, 2
    s_add_u32 s33, s33, s34
    s_add_u32 s33, s33, s57
    v_lshl_add_u32 v16, v18, 3, v1
    v_add_u32 v16, s33, v16
    v_lshlrev_b32 v227, 1, v16
    s_mov_b32 s44, s24
    s_mov_b32 s45, s25
    s_mov_b32 s46, 2304
    s_mov_b32 s47, 0x20000
    s_cmp_ge_u32 s53, 8
    s_cselect_b64 s[64:65], -1, 0
    s_mov_b32 s61, 2147483647
    s_cmp_eq_u32 s56, 1
    s_cselect_b32 s40, s22, s12
    s_cselect_b32 s41, s23, s13
    s_cselect_b32 s74, 262144, 0
    s_cselect_b32 s75, 16384, 0
    s_cselect_b32 s61, 0x7fffffff, s61
    s_lshl_b32 s72, s53, 8
    s_add_u32 s72, s72, s74
    s_lshl_b32 s73, s53, 6
    s_add_u32 s73, s73, s75
    s_lshl_b32 s33, s56, 12
    v_add_u32 v224, s33, v224
    s_lshl_b32 s33, s56, 11
    v_add_u32 v225, s33, v225
    s_lshl_b32 s33, s56, 2
    v_add_u32 v14, s33, v226
    s_lshl_b32 s33, s53, 2
    s_lshl_b64 s[62:63], 15, s33
    v_lshl_add_u32 v16, v15, 1, v13
    v_lshlrev_b32 v16, 8, v16
    v_and_b32 v17, 7, v0
    v_lshl_add_u32 v17, v12, 3, v17
    v_lshl_add_u32 v16, v17, 4, v16
    s_lshl_b32 s33, s56, 12
    s_add_u32 s33, s33, 132096
    v_add_u32 v230, s33, v16
    s_lshl_b32 s34, s59, 8
    s_add_u32 s34, s34, s33
    v_lshlrev_b32 v16, 4, v18
    v_add_u32 v231, s34, v16
    v_mov_b32 v232, s33
    s_mov_b32 s60, 0
    s_cmp_eq_u32 s56, 1
    s_cbranch_scc1 L_wcnt
L_wtrig:
    ds_read_b64 v[12:13], v226 offset:16
    s_add_u32 s60, s60, 1
    s_mov_b32 s33, 3
    s_cmp_ge_u32 s60, 1048576
    s_cbranch_scc1 L_fail
    s_waitcnt lgkmcnt(0)
    v_readfirstlane_b32 s33, v12
    v_readfirstlane_b32 s34, v13
    s_sleep 1
    s_cmp_ge_i32 s33, s61
    s_cbranch_scc1 L_wcnt
    s_cmp_eq_u32 s34, 0x7fffffff
    s_cbranch_scc1 L_wtrig
L_wcnt:
    ds_read_b32 v12, v14 offset:4
    s_add_u32 s60, s60, 1
    s_mov_b32 s33, 4
    s_cmp_ge_u32 s60, 2097152
    s_cbranch_scc1 L_fail
    s_waitcnt lgkmcnt(0)
    v_readfirstlane_b32 s34, v12
    s_nop 3
    s_cmp_eq_u32 s34, 4
    s_cbranch_scc0 L_wcnt
    ds_read_b64 v[36:37], v225 offset:0
    ds_read_b64 v[38:39], v225 offset:512
    ds_read_b64 v[40:41], v225 offset:1024
    ds_read_b64 v[42:43], v225 offset:1536
    ds_read_b128 v[20:23], v224 offset:0
    ds_read_b128 v[24:27], v224 offset:1024
    ds_read_b128 v[28:31], v224 offset:2048
    ds_read_b128 v[32:35], v224 offset:3072
    s_waitcnt lgkmcnt(0)
    v_max3_f32 v44, v36, v38, v40
    v_max_f32 v44, v44, v42
    v_perm_b32 v44, v44, v228, s68
    v_sub_f32 v36, v36, v44
    v_sub_f32 v38, v38, v44
    v_sub_f32 v40, v40, v44
    v_sub_f32 v42, v42, v44
    v_exp_f32 v36, v36
    v_exp_f32 v38, v38
    v_exp_f32 v40, v40
    v_exp_f32 v42, v42
    v_mov_b32_dpp v46, v44 row_ror:8 row_mask:0xf bank_mask:0xf
    v_mul_f32 v45, v36, v37
    v_mul_f32 v48, v36, v20
    v_mul_f32 v49, v36, v21
    v_mul_f32 v50, v36, v22
    v_mul_f32 v51, v36, v23
    v_fmac_f32 v45, v38, v39
    v_fmac_f32 v48, v38, v24
    v_fmac_f32 v49, v38, v25
    v_fmac_f32 v50, v38, v26
    v_fmac_f32 v51, v38, v27
    v_fmac_f32 v45, v40, v41
    v_fmac_f32 v48, v40, v28
    v_fmac_f32 v49, v40, v29
    v_fmac_f32 v50, v40, v30
    v_fmac_f32 v51, v40, v31
    v_fmac_f32 v45, v42, v43
    v_fmac_f32 v48, v42, v32
    v_fmac_f32 v49, v42, v33
    v_fmac_f32 v50, v42, v34
    v_fmac_f32 v51, v42, v35
    v_mov_b32 v12, v45
    v_perm_b32 v52, v48, v228, s68
    v_perm_b32 v53, v49, v228, s68
    v_perm_b32 v54, v50, v228, s68
    v_perm_b32 v55, v51, v228, s68
    buffer_store_dwordx4 v[52:55], v216, s[36:39], s72 offen sc1
    v_permlane32_swap_b32 v45, v12
    v_add_f32 v45, v45, v12
    v_mov_b32 v12, v45
    s_nop 1
    v_permlane16_swap_b32 v45, v12
    v_add_f32 v45, v45, v12
    s_nop 1
    v_mov_b32_dpp v47, v45 row_ror:8 row_mask:0xf bank_mask:0xf
    v_perm_b32 v45, v45, v228, s68
    v_perm_b32 v47, v47, v228, s68
    s_mov_b64 exec, 0xf
    buffer_store_dwordx4 v[44:47], v217, s[36:39], s73 offen sc1
    s_mov_b64 exec, -1
    s_mov_b32 s60, 0
    s_mov_b64 s[50:51], -1
    s_branch L_m0
    s_waitcnt vmcnt(0)
L_m0:
    s_mov_b32 s57, 0
    buffer_load_dwordx4 v[60:63], v223, s[40:43], s57 offen nt
    s_mov_b32 s57, 9216
    buffer_load_dwordx4 v[64:67], v223, s[40:43], s57 offen nt
    s_mov_b32 s57, 18432
    buffer_load_dwordx4 v[68:71], v223, s[40:43], s57 offen nt
    s_mov_b32 s57, 27648
    buffer_load_dwordx4 v[72:75], v223, s[40:43], s57 offen nt
    s_mov_b32 s57, 1152
    buffer_load_dwordx4 v[76:79], v223, s[40:43], s57 offen nt
    s_mov_b32 s57, 10368
    buffer_load_dwordx4 v[80:83], v223, s[40:43], s57 offen nt
    s_mov_b32 s57, 19584
    buffer_load_dwordx4 v[84:87], v223, s[40:43], s57 offen nt
    s_mov_b32 s57, 28800
    buffer_load_dwordx4 v[88:91], v223, s[40:43], s57 offen nt
    s_mov_b32 s57, 2304
    buffer_load_dwordx4 v[92:95], v223, s[40:43], s57 offen nt
    s_mov_b32 s57, 11520
    buffer_load_dwordx4 v[96:99], v223, s[40:43], s57 offen nt
    s_mov_b32 s57, 20736
    buffer_load_dwordx4 v[100:103], v223, s[40:43], s57 offen nt
    s_mov_b32 s57, 29952
    buffer_load_dwordx4 v[104:107], v223, s[40:43], s57 offen nt
    s_mov_b32 s57, 3456
    buffer_load_dwordx4 v[108:111], v223, s[40:43], s57 offen nt
    s_mov_b32 s57, 12672
    buffer_load_dwordx4 v[112:115], v223, s[40:43], s57 offen nt
    s_mov_b32 s57, 21888
    buffer_load_dwordx4 v[116:119], v223, s[40:43], s57 offen nt
    s_mov_b32 s57, 31104
    buffer_load_dwordx4 v[120:123], v223, s[40:43], s57 offen nt
    s_cmp_eq_u32 s58, 3
    s_cbranch_scc1 L_wo2b
    s_waitcnt vmcnt(16)
    s_branch L_p1
L_wo2b:
    s_mov_b32 exec_lo, 0x00ff00ff
    s_mov_b32 exec_hi, 0x00ff00ff
    s_mov_b32 s57, 0
    buffer_load_dwordx4 v[124:127], v223, s[40:43], s57 offen offset:256 nt
    s_mov_b32 s57, 9216
    buffer_load_dwordx4 v[128:131], v223, s[40:43], s57 offen offset:256 nt
    s_mov_b32 s57, 18432
    buffer_load_dwordx4 v[132:135], v223, s[40:43], s57 offen offset:256 nt
    s_mov_b32 s57, 27648
    buffer_load_dwordx4 v[136:139], v223, s[40:43], s57 offen offset:256 nt
    s_mov_b32 s57, 1152
    buffer_load_dwordx4 v[140:143], v223, s[40:43], s57 offen offset:256 nt
    s_mov_b32 s57, 10368
    buffer_load_dwordx4 v[144:147], v223, s[40:43], s57 offen offset:256 nt
    s_mov_b32 s57, 19584
    buffer_load_dwordx4 v[148:151], v223, s[40:43], s57 offen offset:256 nt
    s_mov_b32 s57, 28800
    buffer_load_dwordx4 v[152:155], v223, s[40:43], s57 offen offset:256 nt
    s_mov_b32 s57, 2304
    buffer_load_dwordx4 v[156:159], v223, s[40:43], s57 offen offset:256 nt
    s_mov_b32 s57, 11520
    buffer_load_dwordx4 v[160:163], v223, s[40:43], s57 offen offset:256 nt
    s_mov_b32 s57, 20736
    buffer_load_dwordx4 v[164:167], v223, s[40:43], s57 offen offset:256 nt
    s_mov_b32 s57, 29952
    buffer_load_dwordx4 v[168:171], v223, s[40:43], s57 offen offset:256 nt
    s_mov_b32 s57, 3456
    buffer_load_dwordx4 v[172:175], v223, s[40:43], s57 offen offset:256 nt
    s_mov_b32 s57, 12672
    buffer_load_dwordx4 v[176:179], v223, s[40:43], s57 offen offset:256 nt
    s_mov_b32 s57, 21888
    buffer_load_dwordx4 v[180:183], v223, s[40:43], s57 offen offset:256 nt
    s_mov_b32 s57, 31104
    buffer_load_dwordx4 v[184:187], v223, s[40:43], s57 offen offset:256 nt
    s_mov_b64 exec, -1
    s_waitcnt vmcnt(32)
    s_branch L_p1
L_p1:
    buffer_load_dwordx4 v[204:207], v219, s[36:39], s75 offen sc1
    buffer_load_dwordx4 v[188:191], v218, s[36:39], s74 offen offset:0 sc1
    buffer_load_dwordx4 v[192:195], v218, s[36:39], s74 offen offset:64 sc1
    buffer_load_dwordx4 v[196:199], v218, s[36:39], s74 offen offset:128 sc1
    buffer_load_dwordx4 v[200:203], v218, s[36:39], s74 offen offset:192 sc1
    s_add_u32 s60, s60, 1
    s_mov_b32 s33, 5
    s_cmp_ge_u32 s60, 16384
    s_cbranch_scc1 L_fail
    s_waitcnt vmcnt(0)
L_check:
    v_cmpx_eq_u32_sdwa vcc, v204, v228 src0_sel:BYTE_0 src1_sel:DWORD
    v_cmpx_eq_u32_sdwa vcc, v205, v228 src0_sel:BYTE_0 src1_sel:DWORD
    v_cmpx_eq_u32_sdwa vcc, v206, v228 src0_sel:BYTE_0 src1_sel:DWORD
    v_cmpx_eq_u32_sdwa vcc, v207, v228 src0_sel:BYTE_0 src1_sel:DWORD
    v_cmpx_eq_u32_sdwa vcc, v188, v228 src0_sel:BYTE_0 src1_sel:DWORD
    v_cmpx_eq_u32_sdwa vcc, v189, v228 src0_sel:BYTE_0 src1_sel:DWORD
    v_cmpx_eq_u32_sdwa vcc, v190, v228 src0_sel:BYTE_0 src1_sel:DWORD
    v_cmpx_eq_u32_sdwa vcc, v191, v228 src0_sel:BYTE_0 src1_sel:DWORD
    v_cmpx_eq_u32_sdwa vcc, v192, v228 src0_sel:BYTE_0 src1_sel:DWORD
    v_cmpx_eq_u32_sdwa vcc, v193, v228 src0_sel:BYTE_0 src1_sel:DWORD
    v_cmpx_eq_u32_sdwa vcc, v194, v228 src0_sel:BYTE_0 src1_sel:DWORD
    v_cmpx_eq_u32_sdwa vcc, v195, v228 src0_sel:BYTE_0 src1_sel:DWORD
    v_cmpx_eq_u32_sdwa vcc, v196, v228 src0_sel:BYTE_0 src1_sel:DWORD
    v_cmpx_eq_u32_sdwa vcc, v197, v228 src0_sel:BYTE_0 src1_sel:DWORD
    v_cmpx_eq_u32_sdwa vcc, v198, v228 src0_sel:BYTE_0 src1_sel:DWORD
    v_cmpx_eq_u32_sdwa vcc, v199, v228 src0_sel:BYTE_0 src1_sel:DWORD
    v_cmpx_eq_u32_sdwa vcc, v200, v228 src0_sel:BYTE_0 src1_sel:DWORD
    v_cmpx_eq_u32_sdwa vcc, v201, v228 src0_sel:BYTE_0 src1_sel:DWORD
    v_cmpx_eq_u32_sdwa vcc, v202, v228 src0_sel:BYTE_0 src1_sel:DWORD
    v_cmpx_eq_u32_sdwa vcc, v203, v228 src0_sel:BYTE_0 src1_sel:DWORD
    s_nop 3
    s_andn2_b64 s[50:51], s[50:51], exec
    s_mov_b64 exec, s[50:51]
    s_cbranch_scc1 L_p1
    s_mov_b64 exec, -1
    v_cndmask_b32 v12, v204, v206, s[64:65]
    v_cndmask_b32 v14, v204, v206, s[64:65]
    v_cndmask_b32 v15, v205, v207, s[64:65]
    s_nop 1
    v_max_f32_dpp v12, v12, v12 row_ror:4 row_mask:0xf bank_mask:0xf
    s_nop 1
    v_max_f32_dpp v12, v12, v12 row_ror:8 row_mask:0xf bank_mask:0xf
    v_mov_b32 v13, v12
    s_nop 1
    v_permlane16_swap_b32 v12, v13
    v_max_f32 v12, v12, v13
    v_mov_b32 v13, v12
    s_nop 1
    v_permlane32_swap_b32 v12, v13
    v_max_f32 v12, v12, v13
    v_sub_f32 v14, v14, v12
    v_exp_f32 v14, v14
    s_nop 0
    v_mul_f32 v12, v14, v15
    v_mul_f32 v20, v14, v188
    v_mul_f32 v21, v14, v189
    v_mul_f32 v22, v14, v190
    v_mul_f32 v23, v14, v191
    v_mul_f32 v24, v14, v192
    v_mul_f32 v25, v14, v193
    v_mul_f32 v26, v14, v194
    v_mul_f32 v27, v14, v195
    v_mul_f32 v28, v14, v196
    v_mul_f32 v29, v14, v197
    v_mul_f32 v30, v14, v198
    v_mul_f32 v31, v14, v199
    v_mul_f32 v32, v14, v200
    v_mul_f32 v33, v14, v201
    v_mul_f32 v34, v14, v202
    v_mul_f32 v35, v14, v203
    v_permlane32_swap_b32 v20, v28
    v_permlane32_swap_b32 v21, v29
    v_permlane32_swap_b32 v22, v30
    v_permlane32_swap_b32 v23, v31
    v_permlane32_swap_b32 v24, v32
    v_permlane32_swap_b32 v25, v33
    v_permlane32_swap_b32 v26, v34
    v_permlane32_swap_b32 v27, v35
    v_add_f32 v20, v20, v28
    v_add_f32 v21, v21, v29
    v_add_f32 v22, v22, v30
    v_add_f32 v23, v23, v31
    v_add_f32 v24, v24, v32
    v_add_f32 v25, v25, v33
    v_add_f32 v26, v26, v34
    v_add_f32 v27, v27, v35
    v_add_f32_dpp v12, v12, v12 row_ror:4 row_mask:0xf bank_mask:0xf
    s_nop 0
    v_permlane16_swap_b32 v20, v24
    v_permlane16_swap_b32 v21, v25
    v_permlane16_swap_b32 v22, v26
    v_permlane16_swap_b32 v23, v27
    v_add_f32_dpp v12, v12, v12 row_ror:8 row_mask:0xf bank_mask:0xf
    v_add_f32 v20, v20, v24
    v_add_f32 v21, v21, v25
    v_add_f32 v22, v22, v26
    v_add_f32 v23, v23, v27
    v_mov_b32 v13, v12
    v_add_f32_dpp v20, v20, v20 row_ror:4 row_mask:0xf bank_mask:0xf
    v_add_f32_dpp v21, v21, v21 row_ror:4 row_mask:0xf bank_mask:0xf
    v_add_f32_dpp v22, v22, v22 row_ror:4 row_mask:0xf bank_mask:0xf
    v_add_f32_dpp v23, v23, v23 row_ror:4 row_mask:0xf bank_mask:0xf
    v_permlane16_swap_b32 v12, v13
    v_add_f32 v12, v12, v13
    v_mov_b32 v13, v12
    v_add_f32_dpp v20, v20, v20 row_ror:8 row_mask:0xf bank_mask:0xf
    v_add_f32_dpp v21, v21, v21 row_ror:8 row_mask:0xf bank_mask:0xf
    v_add_f32_dpp v22, v22, v22 row_ror:8 row_mask:0xf bank_mask:0xf
    v_add_f32_dpp v23, v23, v23 row_ror:8 row_mask:0xf bank_mask:0xf
    v_permlane32_swap_b32 v12, v13
    v_add_f32 v12, v12, v13
    v_rcp_f32 v12, v12
    s_nop 0
    v_mul_f32 v20, v12, v20
    v_mul_f32 v21, v12, v21
    v_mul_f32 v22, v12, v22
    v_mul_f32 v23, v12, v23
    v_cvt_pk_bf16_f32 v20, v20, v21
    v_cvt_pk_bf16_f32 v21, v22, v23
    s_nop 0
    v_mov_b32_dpp v208, v20 quad_perm:[0,0,0,0] row_mask:0xf bank_mask:0xf
    v_mov_b32_dpp v209, v21 quad_perm:[0,0,0,0] row_mask:0xf bank_mask:0xf
    v_mov_b32_dpp v210, v20 quad_perm:[1,1,1,1] row_mask:0xf bank_mask:0xf
    v_mov_b32_dpp v211, v21 quad_perm:[1,1,1,1] row_mask:0xf bank_mask:0xf
    v_mov_b32_dpp v212, v20 quad_perm:[2,2,2,2] row_mask:0xf bank_mask:0xf
    v_mov_b32_dpp v213, v21 quad_perm:[2,2,2,2] row_mask:0xf bank_mask:0xf
    v_mov_b32_dpp v214, v20 quad_perm:[3,3,3,3] row_mask:0xf bank_mask:0xf
    v_mov_b32_dpp v215, v21 quad_perm:[3,3,3,3] row_mask:0xf bank_mask:0xf
L_op0:
    s_waitcnt vmcnt(0)
    s_cmp_eq_u32 s58, 3
    s_cbranch_scc1 L_op2
    v_perm_b32 v52, v208, v208, v4
    v_perm_b32 v53, v208, v208, v5
    v_perm_b32 v54, v208, v208, v6
    v_perm_b32 v55, v208, v208, v7
    v_perm_b32 v56, v208, v208, v8
    v_perm_b32 v57, v208, v208, v9
    v_perm_b32 v58, v208, v208, v10
    v_perm_b32 v59, v208, v208, v11
    v_mfma_f32_16x16x32_bf16 v[44:47], v[52:55], v[60:63], 0
    v_perm_b32 v52, v209, v209, v4
    v_perm_b32 v53, v209, v209, v5
    v_perm_b32 v54, v209, v209, v6
    v_perm_b32 v55, v209, v209, v7
    v_mfma_f32_16x16x32_bf16 v[44:47], v[56:59], v[64:67], v[44:47]
    v_perm_b32 v56, v209, v209, v8
    v_perm_b32 v57, v209, v209, v9
    v_perm_b32 v58, v209, v209, v10
    v_perm_b32 v59, v209, v209, v11
    v_mfma_f32_16x16x32_bf16 v[44:47], v[52:55], v[68:71], v[44:47]
    v_perm_b32 v52, v210, v210, v4
    v_perm_b32 v53, v210, v210, v5
    v_perm_b32 v54, v210, v210, v6
    v_perm_b32 v55, v210, v210, v7
    v_mfma_f32_16x16x32_bf16 v[44:47], v[56:59], v[72:75], v[44:47]
    v_perm_b32 v56, v210, v210, v8
    v_perm_b32 v57, v210, v210, v9
    v_perm_b32 v58, v210, v210, v10
    v_perm_b32 v59, v210, v210, v11
    v_mfma_f32_16x16x32_bf16 v[44:47], v[52:55], v[76:79], v[44:47]
    v_perm_b32 v52, v211, v211, v4
    v_perm_b32 v53, v211, v211, v5
    v_perm_b32 v54, v211, v211, v6
    v_perm_b32 v55, v211, v211, v7
    v_mfma_f32_16x16x32_bf16 v[44:47], v[56:59], v[80:83], v[44:47]
    v_perm_b32 v56, v211, v211, v8
    v_perm_b32 v57, v211, v211, v9
    v_perm_b32 v58, v211, v211, v10
    v_perm_b32 v59, v211, v211, v11
    v_mfma_f32_16x16x32_bf16 v[44:47], v[52:55], v[84:87], v[44:47]
    v_perm_b32 v52, v212, v212, v4
    v_perm_b32 v53, v212, v212, v5
    v_perm_b32 v54, v212, v212, v6
    v_perm_b32 v55, v212, v212, v7
    v_mfma_f32_16x16x32_bf16 v[44:47], v[56:59], v[88:91], v[44:47]
    v_perm_b32 v56, v212, v212, v8
    v_perm_b32 v57, v212, v212, v9
    v_perm_b32 v58, v212, v212, v10
    v_perm_b32 v59, v212, v212, v11
    v_mfma_f32_16x16x32_bf16 v[44:47], v[52:55], v[92:95], v[44:47]
    v_perm_b32 v52, v213, v213, v4
    v_perm_b32 v53, v213, v213, v5
    v_perm_b32 v54, v213, v213, v6
    v_perm_b32 v55, v213, v213, v7
    v_mfma_f32_16x16x32_bf16 v[44:47], v[56:59], v[96:99], v[44:47]
    v_perm_b32 v56, v213, v213, v8
    v_perm_b32 v57, v213, v213, v9
    v_perm_b32 v58, v213, v213, v10
    v_perm_b32 v59, v213, v213, v11
    v_mfma_f32_16x16x32_bf16 v[44:47], v[52:55], v[100:103], v[44:47]
    v_perm_b32 v52, v214, v214, v4
    v_perm_b32 v53, v214, v214, v5
    v_perm_b32 v54, v214, v214, v6
    v_perm_b32 v55, v214, v214, v7
    v_mfma_f32_16x16x32_bf16 v[44:47], v[56:59], v[104:107], v[44:47]
    v_perm_b32 v56, v214, v214, v8
    v_perm_b32 v57, v214, v214, v9
    v_perm_b32 v58, v214, v214, v10
    v_perm_b32 v59, v214, v214, v11
    v_mfma_f32_16x16x32_bf16 v[44:47], v[52:55], v[108:111], v[44:47]
    v_perm_b32 v52, v215, v215, v4
    v_perm_b32 v53, v215, v215, v5
    v_perm_b32 v54, v215, v215, v6
    v_perm_b32 v55, v215, v215, v7
    v_mfma_f32_16x16x32_bf16 v[44:47], v[56:59], v[112:115], v[44:47]
    v_perm_b32 v56, v215, v215, v8
    v_perm_b32 v57, v215, v215, v9
    v_perm_b32 v58, v215, v215, v10
    v_perm_b32 v59, v215, v215, v11
    v_mfma_f32_16x16x32_bf16 v[44:47], v[52:55], v[116:119], v[44:47]
    s_nop 1
    v_mfma_f32_16x16x32_bf16 v[44:47], v[56:59], v[120:123], v[44:47]
    s_nop 7
    s_branch L_op3
L_op2:
    v_perm_b32 v52, v208, v208, v4
    v_perm_b32 v53, v208, v208, v5
    v_perm_b32 v54, v208, v208, v6
    v_perm_b32 v55, v208, v208, v7
    v_perm_b32 v56, v208, v208, v8
    v_perm_b32 v57, v208, v208, v9
    v_perm_b32 v58, v208, v208, v10
    v_perm_b32 v59, v208, v208, v11
    v_mfma_f32_16x16x32_bf16 v[44:47], v[52:55], v[60:63], 0
    v_mfma_f32_16x16x32_bf16 v[48:51], v[52:55], v[124:127], 0
    v_perm_b32 v52, v209, v209, v4
    v_perm_b32 v53, v209, v209, v5
    v_perm_b32 v54, v209, v209, v6
    v_perm_b32 v55, v209, v209, v7
    v_mfma_f32_16x16x32_bf16 v[44:47], v[56:59], v[64:67], v[44:47]
    v_mfma_f32_16x16x32_bf16 v[48:51], v[56:59], v[128:131], v[48:51]
    v_perm_b32 v56, v209, v209, v8
    v_perm_b32 v57, v209, v209, v9
    v_perm_b32 v58, v209, v209, v10
    v_perm_b32 v59, v209, v209, v11
    v_mfma_f32_16x16x32_bf16 v[44:47], v[52:55], v[68:71], v[44:47]
    v_mfma_f32_16x16x32_bf16 v[48:51], v[52:55], v[132:135], v[48:51]
    v_perm_b32 v52, v210, v210, v4
    v_perm_b32 v53, v210, v210, v5
    v_perm_b32 v54, v210, v210, v6
    v_perm_b32 v55, v210, v210, v7
    v_mfma_f32_16x16x32_bf16 v[44:47], v[56:59], v[72:75], v[44:47]
    v_mfma_f32_16x16x32_bf16 v[48:51], v[56:59], v[136:139], v[48:51]
    v_perm_b32 v56, v210, v210, v8
    v_perm_b32 v57, v210, v210, v9
    v_perm_b32 v58, v210, v210, v10
    v_perm_b32 v59, v210, v210, v11
    v_mfma_f32_16x16x32_bf16 v[44:47], v[52:55], v[76:79], v[44:47]
    v_mfma_f32_16x16x32_bf16 v[48:51], v[52:55], v[140:143], v[48:51]
    v_perm_b32 v52, v211, v211, v4
    v_perm_b32 v53, v211, v211, v5
    v_perm_b32 v54, v211, v211, v6
    v_perm_b32 v55, v211, v211, v7
    v_mfma_f32_16x16x32_bf16 v[44:47], v[56:59], v[80:83], v[44:47]
    v_mfma_f32_16x16x32_bf16 v[48:51], v[56:59], v[144:147], v[48:51]
    v_perm_b32 v56, v211, v211, v8
    v_perm_b32 v57, v211, v211, v9
    v_perm_b32 v58, v211, v211, v10
    v_perm_b32 v59, v211, v211, v11
    v_mfma_f32_16x16x32_bf16 v[44:47], v[52:55], v[84:87], v[44:47]
    v_mfma_f32_16x16x32_bf16 v[48:51], v[52:55], v[148:151], v[48:51]
    v_perm_b32 v52, v212, v212, v4
    v_perm_b32 v53, v212, v212, v5
    v_perm_b32 v54, v212, v212, v6
    v_perm_b32 v55, v212, v212, v7
    v_mfma_f32_16x16x32_bf16 v[44:47], v[56:59], v[88:91], v[44:47]
    v_mfma_f32_16x16x32_bf16 v[48:51], v[56:59], v[152:155], v[48:51]
    v_perm_b32 v56, v212, v212, v8
    v_perm_b32 v57, v212, v212, v9
    v_perm_b32 v58, v212, v212, v10
    v_perm_b32 v59, v212, v212, v11
    v_mfma_f32_16x16x32_bf16 v[44:47], v[52:55], v[92:95], v[44:47]
    v_mfma_f32_16x16x32_bf16 v[48:51], v[52:55], v[156:159], v[48:51]
    v_perm_b32 v52, v213, v213, v4
    v_perm_b32 v53, v213, v213, v5
    v_perm_b32 v54, v213, v213, v6
    v_perm_b32 v55, v213, v213, v7
    v_mfma_f32_16x16x32_bf16 v[44:47], v[56:59], v[96:99], v[44:47]
    v_mfma_f32_16x16x32_bf16 v[48:51], v[56:59], v[160:163], v[48:51]
    v_perm_b32 v56, v213, v213, v8
    v_perm_b32 v57, v213, v213, v9
    v_perm_b32 v58, v213, v213, v10
    v_perm_b32 v59, v213, v213, v11
    v_mfma_f32_16x16x32_bf16 v[44:47], v[52:55], v[100:103], v[44:47]
    v_mfma_f32_16x16x32_bf16 v[48:51], v[52:55], v[164:167], v[48:51]
    v_perm_b32 v52, v214, v214, v4
    v_perm_b32 v53, v214, v214, v5
    v_perm_b32 v54, v214, v214, v6
    v_perm_b32 v55, v214, v214, v7
    v_mfma_f32_16x16x32_bf16 v[44:47], v[56:59], v[104:107], v[44:47]
    v_mfma_f32_16x16x32_bf16 v[48:51], v[56:59], v[168:171], v[48:51]
    v_perm_b32 v56, v214, v214, v8
    v_perm_b32 v57, v214, v214, v9
    v_perm_b32 v58, v214, v214, v10
    v_perm_b32 v59, v214, v214, v11
    v_mfma_f32_16x16x32_bf16 v[44:47], v[52:55], v[108:111], v[44:47]
    v_mfma_f32_16x16x32_bf16 v[48:51], v[52:55], v[172:175], v[48:51]
    v_perm_b32 v52, v215, v215, v4
    v_perm_b32 v53, v215, v215, v5
    v_perm_b32 v54, v215, v215, v6
    v_perm_b32 v55, v215, v215, v7
    v_mfma_f32_16x16x32_bf16 v[44:47], v[56:59], v[112:115], v[44:47]
    v_mfma_f32_16x16x32_bf16 v[48:51], v[56:59], v[176:179], v[48:51]
    v_perm_b32 v56, v215, v215, v8
    v_perm_b32 v57, v215, v215, v9
    v_perm_b32 v58, v215, v215, v10
    v_perm_b32 v59, v215, v215, v11
    v_mfma_f32_16x16x32_bf16 v[44:47], v[52:55], v[116:119], v[44:47]
    v_mfma_f32_16x16x32_bf16 v[48:51], v[52:55], v[180:183], v[48:51]
    s_nop 1
    v_mfma_f32_16x16x32_bf16 v[44:47], v[56:59], v[120:123], v[44:47]
    v_mfma_f32_16x16x32_bf16 v[48:51], v[56:59], v[184:187], v[48:51]
    s_nop 7
    v_perm_b32 v24, v48, v228, s68
    v_perm_b32 v25, v49, v228, s68
    v_perm_b32 v26, v50, v228, s68
    v_perm_b32 v27, v51, v228, s68
    s_mov_b64 exec, 0x00ff00ff
    buffer_store_dwordx4 v[24:27], v221, s[36:39], s32 offen sc1
    s_mov_b64 exec, -1
L_op3:
    v_perm_b32 v20, v44, v228, s68
    v_perm_b32 v21, v45, v228, s68
    v_perm_b32 v22, v46, v228, s68
    v_perm_b32 v23, v47, v228, s68
    s_mov_b32 exec_hi, 0
    buffer_store_dwordx4 v[20:23], v220, s[36:39], s32 offen sc1
    s_mov_b64 exec, -1
    s_cmp_lt_u32 s48, 36
    s_cbranch_scc0 L_fin2
    s_waitcnt vmcnt(0)
    s_mov_b32 s60, 0
    s_mov_b64 s[50:51], -1
    s_mov_b64 exec, -1
L_p2:
    buffer_load_dwordx4 v[188:191], v222, s[36:39], 0 offen offset:0 sc1
    buffer_load_dwordx4 v[192:195], v222, s[36:39], 0 offen offset:1024 sc1
    buffer_load_dwordx4 v[196:199], v222, s[36:39], 0 offen offset:2048 sc1
    buffer_load_dwordx4 v[200:203], v222, s[36:39], 0 offen offset:3072 sc1
    s_add_u32 s60, s60, 1
    s_mov_b32 s33, 6
    s_cmp_ge_u32 s60, 16384
    s_cbranch_scc1 L_fail
    s_waitcnt vmcnt(3)
    v_cmpx_eq_u32_sdwa vcc, v188, v228 src0_sel:BYTE_0 src1_sel:DWORD
    v_cmpx_eq_u32_sdwa vcc, v189, v228 src0_sel:BYTE_0 src1_sel:DWORD
    v_cmpx_eq_u32_sdwa vcc, v190, v228 src0_sel:BYTE_0 src1_sel:DWORD
    v_cmpx_eq_u32_sdwa vcc, v191, v228 src0_sel:BYTE_0 src1_sel:DWORD
    s_waitcnt vmcnt(2)
    v_cmpx_eq_u32_sdwa vcc, v192, v228 src0_sel:BYTE_0 src1_sel:DWORD
    v_cmpx_eq_u32_sdwa vcc, v193, v228 src0_sel:BYTE_0 src1_sel:DWORD
    v_cmpx_eq_u32_sdwa vcc, v194, v228 src0_sel:BYTE_0 src1_sel:DWORD
    v_cmpx_eq_u32_sdwa vcc, v195, v228 src0_sel:BYTE_0 src1_sel:DWORD
    s_waitcnt vmcnt(1)
    v_cmpx_eq_u32_sdwa vcc, v196, v228 src0_sel:BYTE_0 src1_sel:DWORD
    v_cmpx_eq_u32_sdwa vcc, v197, v228 src0_sel:BYTE_0 src1_sel:DWORD
    v_cmpx_eq_u32_sdwa vcc, v198, v228 src0_sel:BYTE_0 src1_sel:DWORD
    v_cmpx_eq_u32_sdwa vcc, v199, v228 src0_sel:BYTE_0 src1_sel:DWORD
    s_waitcnt vmcnt(0)
    v_cmpx_eq_u32_sdwa vcc, v200, v228 src0_sel:BYTE_0 src1_sel:DWORD
    v_cmpx_eq_u32_sdwa vcc, v201, v228 src0_sel:BYTE_0 src1_sel:DWORD
    v_cmpx_eq_u32_sdwa vcc, v202, v228 src0_sel:BYTE_0 src1_sel:DWORD
    v_cmpx_eq_u32_sdwa vcc, v203, v228 src0_sel:BYTE_0 src1_sel:DWORD
    s_nop 3
    s_andn2_b64 s[50:51], s[50:51], exec
    s_mov_b64 exec, s[50:51]
    s_cbranch_scc1 L_p2
    s_mov_b64 exec, -1
    v_add_f32 v208, v188, v196
    v_add_f32 v209, v189, v197
    v_add_f32 v210, v190, v198
    v_add_f32 v211, v191, v199
    v_add_f32 v212, v192, v200
    v_add_f32 v213, v193, v201
    v_add_f32 v214, v194, v202
    v_add_f32 v215, v195, v203
    v_add_f32 v208, v208, v212
    v_add_f32 v209, v209, v213
    v_add_f32 v210, v210, v214
    v_add_f32 v211, v211, v215
    s_nop 1
    v_permlane32_swap_b32 v208, v210
    v_permlane32_swap_b32 v209, v211
    v_add_f32 v208, v208, v210
    v_add_f32 v209, v209, v211
    s_nop 1
    v_permlane16_swap_b32 v208, v209
    v_add_f32 v208, v208, v209
    s_nop 1
    v_add_f32_dpp v208, v208, v208 row_ror:4 row_mask:0xf bank_mask:0xf
    s_nop 1
    v_add_f32_dpp v208, v208, v208 row_ror:8 row_mask:0xf bank_mask:0xf
    v_cvt_pk_bf16_f32 v208, v208, v208
    s_mov_b32 exec_lo, 0x000f000f
    s_mov_b32 exec_hi, 0x000f000f
    buffer_store_short v208, v227, s[44:47], s49 offen
    s_mov_b64 exec, -1
L_fin:
    s_cmp_eq_u32 s2, 0
    s_cbranch_scc0 L_fin2
    v_mov_b32 v12, 0
    s_mov_b64 exec, 1
    buffer_store_dword v228, v12, s[36:39], 0 offen sc1
    s_mov_b64 exec, -1
L_fin2:
    s_endpgm
L_fail:
    v_mov_b32 v12, s33
    v_mov_b32 v13, 0
    s_mov_b64 exec, 1
    global_store_dword v13, v12, s[26:27]
L_end:
    s_endpgm
L_others:
    s_cmp_eq_u32 s54, 6
    s_cbranch_scc1 L_awave
    s_cmp_eq_u32 s54, 3
    s_cbranch_scc0 L_consumer
    s_setprio 3
    v_xor_b32 v12, v2, v1
    v_and_b32 v13, 1, v1
    v_lshlrev_b32 v13, 8, v13
    v_lshrrev_b32 v14, 1, v1
    v_lshl_add_u32 v13, v14, 9, v13
    v_lshl_add_u32 v15, v2, 4, v13
    v_xor_b32 v14, 0, v12
    v_lshl_add_u32 v14, v14, 4, v13
    v_add_u32 v20, 0, v14
    v_add_u32 v24, 0, v15
    v_add_u32 v28, 0, v14
    v_add_u32 v32, 0, v14
    v_xor_b32 v14, 4, v12
    v_lshl_add_u32 v14, v14, 4, v13
    v_add_u32 v21, 0, v14
    v_add_u32 v25, 0, v15
    v_add_u32 v29, 0, v14
    v_add_u32 v33, 0, v14
    v_xor_b32 v14, 8, v12
    v_lshl_add_u32 v14, v14, 4, v13
    v_add_u32 v22, 30720, v14
    v_add_u32 v26, 30720, v15
    v_add_u32 v30, 30720, v14
    v_add_u32 v34, 30720, v14
    v_xor_b32 v14, 12, v12
    v_lshl_add_u32 v14, v14, 4, v13
    v_add_u32 v23, 30720, v14
    v_add_u32 v27, 30720, v15
    v_add_u32 v31, 30720, v14
    v_add_u32 v35, 30720, v14
    v_mov_b32 v36, 158720
    v_mov_b32 v41, 0x7fffffff
    v_mov_b32 v37, 0x200000
    v_mov_b32 v12, 0
    v_mov_b32 v13, 0
    v_mov_b32 v14, 0
    v_mov_b32 v15, 0
    v_mov_b32 v16, 0
    v_mov_b32 v17, 0x7fffffff
    ds_write_b128 v36, v[12:15]
    ds_write_b128 v36, v[12:15] offset:32
    ds_write_b64 v36, v[16:17] offset:16
    s_lshl_b32 s60, s52, 23
    s_mul_i32 s70, s2, 3
    s_lshr_b32 s34, s70, 4
    s_xor_b32 s70, s70, s34
    s_and_b32 s70, s70, 31
    s_lshl_b32 s59, s53, 19
    s_add_u32 s59, s59, s60
    s_lshl_b32 s68, s53, 16
    s_add_u32 s68, s68, s60
    s_add_u32 s68, s68, 7340032
    s_add_u32 s60, s60, 458752
    s_lshr_b32 s61, s2, 4
    s_mul_i32 s61, s61, 256
    s_add_u32 s61, s61, 1114112
    s_mul_i32 s58, s52, 13
    s_lshr_b32 s34, s53, 4
    s_add_u32 s58, s58, s34
    s_and_b32 s71, s70, 7
    s_mov_b32 s69, 8
    s_mov_b32 s31, 1
    s_mov_b32 s67, 0
    s_mov_b32 s56, 0
    s_mov_b32 s65, 0
    s_mov_b32 s66, 0
    s_mov_b32 s42, 0x8000000
    s_mov_b32 s43, 0x20000
    s_mov_b32 s46, 0x8000000
    s_mov_b32 s47, 0x20000
    s_mov_b32 s38, 0x200000
    s_mov_b32 s39, 0x20000
    s_waitcnt lgkmcnt(0)
    s_mov_b32 s40, s6
    s_mov_b32 s41, s7
    s_mov_b32 s44, s40
    s_mov_b32 s45, s41
    s_mov_b32 s36, s28
    s_mov_b32 s37, s29
L_round:
    s_waitcnt vmcnt(18)
    s_sub_u32 s33, s56, 4
    s_max_i32 s33, s33, s67
    v_mov_b32 v40, s33
    ds_write_b64 v36, v[40:41] offset:16
    s_cmp_ge_u32 s65, 31
    s_cbranch_scc0 L_st0
    s_waitcnt vmcnt(17)
    s_cmp_ge_u32 s65, 32
    s_cbranch_scc0 L_st0
    v_readfirstlane_b32 s71, v38
    s_nop 3
    s_cmp_ge_u32 s71, 128
    s_cbranch_scc1 L_ldone
    s_lshr_b32 s33, s71, 3
    s_and_b32 s71, s71, 7
    s_mul_i32 s33, s33, 5
    s_add_u32 s33, s33, s58
    s_and_b32 s33, s33, 15
    s_lshl_b32 s33, s33, 19
    s_add_u32 s68, s33, s60
L_st0:
    s_lshr_b32 s57, s71, 3
    s_lshl_b32 s57, s57, 16
    s_bfe_u32 s33, s71, 0x10000
    s_lshl_b32 s33, s33, 14
    s_add_u32 s57, s57, s33
    s_bfe_u32 s33, s71, 0x10001
    s_lshl_b32 s33, s33, 13
    s_add_u32 s57, s57, s33
    s_bfe_u32 s33, s71, 0x10002
    s_lshl_b32 s33, s33, 12
    s_add_u32 s57, s57, s33
    s_add_u32 m0, s66, 0
    s_add_u32 s57, s57, s68
    buffer_load_dwordx4 v28, s[40:43], s57 offen offset:0 nt lds
    buffer_load_dwordx4 v30, s[40:43], s57 offen offset:2048 nt lds
    buffer_load_dwordx4 v29, s[40:43], s57 offen offset:1024 nt lds
    buffer_load_dwordx4 v31, s[40:43], s57 offen offset:3072 nt lds
    s_add_u32 m0, s66, 4096
    s_add_u32 s57, s57, 2048
    buffer_load_dwordx4 v28, s[40:43], s57 offen offset:0 nt lds
    buffer_load_dwordx4 v30, s[40:43], s57 offen offset:2048 nt lds
    buffer_load_dwordx4 v29, s[40:43], s57 offen offset:1024 nt lds
    buffer_load_dwordx4 v31, s[40:43], s57 offen offset:3072 nt lds
    s_add_u32 s56, s56, 2
    s_add_u32 s71, s71, s31
    s_cmp_eq_u32 s71, s69
    s_cselect_b32 s71, 0, s71
    s_waitcnt vmcnt(17)
    s_sub_u32 s33, s56, 4
    s_max_i32 s33, s33, s67
    v_mov_b32 v40, s33
    ds_write_b64 v36, v[40:41] offset:16
    s_lshr_b32 s57, s71, 3
    s_lshl_b32 s57, s57, 16
    s_bfe_u32 s33, s71, 0x10000
    s_lshl_b32 s33, s33, 14
    s_add_u32 s57, s57, s33
    s_bfe_u32 s33, s71, 0x10001
    s_lshl_b32 s33, s33, 13
    s_add_u32 s57, s57, s33
    s_bfe_u32 s33, s71, 0x10002
    s_lshl_b32 s33, s33, 12
    s_add_u32 s57, s57, s33
    s_add_u32 m0, s66, 8192
    s_add_u32 s57, s57, s68
    buffer_load_dwordx4 v32, s[44:47], s57 offen offset:0 nt lds
    buffer_load_dwordx4 v34, s[44:47], s57 offen offset:2048 nt lds
    buffer_load_dwordx4 v33, s[44:47], s57 offen offset:1024 nt lds
    buffer_load_dwordx4 v35, s[44:47], s57 offen offset:3072 nt lds
    s_add_u32 m0, s66, 12288
    s_add_u32 s57, s57, 2048
    buffer_load_dwordx4 v32, s[44:47], s57 offen offset:0 nt lds
    buffer_load_dwordx4 v34, s[44:47], s57 offen offset:2048 nt lds
    buffer_load_dwordx4 v33, s[44:47], s57 offen offset:1024 nt lds
    buffer_load_dwordx4 v35, s[44:47], s57 offen offset:3072 nt lds
    s_mov_b64 exec, 1
    v_mov_b32 v38, 1
    buffer_atomic_add v38, v37, s[36:39], 0 offen sc0
    s_mov_b64 exec, -1
    s_add_u32 s56, s56, 2
    s_add_u32 s71, s71, s31
    s_cmp_eq_u32 s71, s69
    s_cselect_b32 s71, 0, s71
    ds_read_b128 v[44:47], v36 offset:32
    s_waitcnt vmcnt(18)
    s_sub_u32 s33, s56, 4
    s_max_i32 s33, s33, s67
    v_mov_b32 v40, s33
    ds_write_b64 v36, v[40:41] offset:16
    s_cmp_ge_u32 s65, 31
    s_cbranch_scc0 L_st1
    s_waitcnt vmcnt(17)
    s_cmp_ge_u32 s65, 32
    s_cbranch_scc0 L_st1
    v_readfirstlane_b32 s71, v39
    s_nop 3
    s_cmp_ge_u32 s71, 128
    s_cbranch_scc1 L_ldone
    s_lshr_b32 s33, s71, 3
    s_and_b32 s71, s71, 7
    s_mul_i32 s33, s33, 5
    s_add_u32 s33, s33, s58
    s_and_b32 s33, s33, 15
    s_lshl_b32 s33, s33, 19
    s_add_u32 s68, s33, s60
L_st1:
    s_lshr_b32 s57, s71, 3
    s_lshl_b32 s57, s57, 16
    s_bfe_u32 s33, s71, 0x10000
    s_lshl_b32 s33, s33, 14
    s_add_u32 s57, s57, s33
    s_bfe_u32 s33, s71, 0x10001
    s_lshl_b32 s33, s33, 13
    s_add_u32 s57, s57, s33
    s_bfe_u32 s33, s71, 0x10002
    s_lshl_b32 s33, s33, 12
    s_add_u32 s57, s57, s33
    s_add_u32 m0, s66, 16384
    s_add_u32 s57, s57, s68
    buffer_load_dwordx4 v28, s[40:43], s57 offen offset:0 nt lds
    buffer_load_dwordx4 v30, s[40:43], s57 offen offset:2048 nt lds
    buffer_load_dwordx4 v29, s[40:43], s57 offen offset:1024 nt lds
    buffer_load_dwordx4 v31, s[40:43], s57 offen offset:3072 nt lds
    s_add_u32 m0, s66, 20480
    s_add_u32 s57, s57, 2048
    buffer_load_dwordx4 v28, s[40:43], s57 offen offset:0 nt lds
    buffer_load_dwordx4 v30, s[40:43], s57 offen offset:2048 nt lds
    buffer_load_dwordx4 v29, s[40:43], s57 offen offset:1024 nt lds
    buffer_load_dwordx4 v31, s[40:43], s57 offen offset:3072 nt lds
    s_add_u32 s56, s56, 2
    s_add_u32 s71, s71, s31
    s_cmp_eq_u32 s71, s69
    s_cselect_b32 s71, 0, s71
    s_cmp_eq_u32 s65, 0
    s_cbranch_scc0 L_nobar
    s_barrier
L_nobar:
    s_waitcnt vmcnt(17)
    s_sub_u32 s33, s56, 4
    s_max_i32 s33, s33, s67
    v_mov_b32 v40, s33
    ds_write_b64 v36, v[40:41] offset:16
    s_lshr_b32 s57, s71, 3
    s_lshl_b32 s57, s57, 16
    s_bfe_u32 s33, s71, 0x10000
    s_lshl_b32 s33, s33, 14
    s_add_u32 s57, s57, s33
    s_bfe_u32 s33, s71, 0x10001
    s_lshl_b32 s33, s33, 13
    s_add_u32 s57, s57, s33
    s_bfe_u32 s33, s71, 0x10002
    s_lshl_b32 s33, s33, 12
    s_add_u32 s57, s57, s33
    s_add_u32 m0, s66, 24576
    s_add_u32 s57, s57, s68
    buffer_load_dwordx4 v32, s[44:47], s57 offen offset:0 nt lds
    buffer_load_dwordx4 v34, s[44:47], s57 offen offset:2048 nt lds
    buffer_load_dwordx4 v33, s[44:47], s57 offen offset:1024 nt lds
    buffer_load_dwordx4 v35, s[44:47], s57 offen offset:3072 nt lds
    s_add_u32 m0, s66, 28672
    s_add_u32 s57, s57, 2048
    buffer_load_dwordx4 v32, s[44:47], s57 offen offset:0 nt lds
    buffer_load_dwordx4 v34, s[44:47], s57 offen offset:2048 nt lds
    buffer_load_dwordx4 v33, s[44:47], s57 offen offset:1024 nt lds
    buffer_load_dwordx4 v35, s[44:47], s57 offen offset:3072 nt lds
    s_mov_b64 exec, 1
    v_mov_b32 v39, 1
    buffer_atomic_add v39, v37, s[36:39], 0 offen sc0
    s_mov_b64 exec, -1
    s_add_u32 s56, s56, 2
    s_add_u32 s71, s71, s31
    s_cmp_eq_u32 s71, s69
    s_cselect_b32 s71, 0, s71
    s_add_u32 s65, s65, 1
    s_add_u32 s66, s66, 32768
    s_and_b32 s66, s66, 131071
    s_cmp_ge_u32 s65, 31
    s_cselect_b32 s62, s61, 0x200000
    v_mov_b32 v37, s62
    s_cmp_eq_u32 s65, 2
    s_cbranch_scc1 L_ph1
    s_cmp_eq_u32 s65, 4
    s_cbranch_scc1 L_ph2
    s_cmp_eq_u32 s65, 18
    s_cbranch_scc1 L_ph3
    s_cmp_eq_u32 s65, 32
    s_cbranch_scc1 L_ph4
L_phd:
    s_mov_b32 s64, 0
L_space:
    s_waitcnt lgkmcnt(0)
    v_min3_u32 v12, v44, v45, v46
    v_min_u32 v12, v12, v47
    s_nop 0
    v_readfirstlane_b32 s33, v12
    s_nop 3
    s_add_u32 s33, s33, 3
    s_cmp_ge_u32 s33, s65
    s_cbranch_scc1 L_round
    s_waitcnt vmcnt(0)
    s_mov_b32 s67, s56
    v_mov_b32 v40, s56
    ds_write_b64 v36, v[40:41] offset:16
    ds_read_b128 v[44:47], v36 offset:32
    s_add_u32 s64, s64, 1
    s_cmp_lt_u32 s64, 1048576
    s_cbranch_scc1 L_space
    s_endpgm
L_ph1:
    s_mov_b64 s[40:41], s[8:9]
    s_mov_b64 s[44:45], s[8:9]
    v_mov_b32 v28, v24
    v_mov_b32 v32, v24
    v_mov_b32 v29, v25
    v_mov_b32 v33, v25
    v_mov_b32 v30, v26
    v_mov_b32 v34, v26
    v_mov_b32 v31, v27
    v_mov_b32 v35, v27
    s_branch L_phd
L_ph2:
    s_mov_b64 s[40:41], s[16:17]
    s_mov_b64 s[44:45], s[16:17]
    v_mov_b32 v28, v20
    v_mov_b32 v32, v20
    v_mov_b32 v29, v21
    v_mov_b32 v33, v21
    v_mov_b32 v30, v22
    v_mov_b32 v34, v22
    v_mov_b32 v31, v23
    v_mov_b32 v35, v23
    s_mov_b32 s68, s59
    s_mov_b32 s71, s70
    s_mov_b32 s69, 56
    s_branch L_phd
L_ph3:
    s_mov_b64 s[40:41], s[18:19]
    s_mov_b64 s[44:45], s[18:19]
    v_mov_b32 v28, v24
    v_mov_b32 v32, v24
    v_mov_b32 v29, v25
    v_mov_b32 v33, v25
    v_mov_b32 v30, v26
    v_mov_b32 v34, v26
    v_mov_b32 v31, v27
    v_mov_b32 v35, v27
    s_branch L_phd
L_ph4:
    s_mov_b64 s[40:41], s[16:17]
    s_mov_b64 s[44:45], s[18:19]
    v_mov_b32 v28, v20
    v_mov_b32 v32, v24
    v_mov_b32 v29, v21
    v_mov_b32 v33, v25
    v_mov_b32 v30, v22
    v_mov_b32 v34, v26
    v_mov_b32 v31, v23
    v_mov_b32 v35, v27
    s_mov_b32 s31, 0
    s_mov_b32 s69, -1
    s_branch L_phd
L_ldone:
    v_mov_b32 v41, s56
    s_sub_u32 s33, s56, 4
    s_max_i32 s33, s33, s67
    v_mov_b32 v40, s33
    ds_write_b64 v36, v[40:41] offset:16
    s_waitcnt vmcnt(9)
    s_sub_u32 s33, s56, 2
    s_max_i32 s33, s33, s67
    v_mov_b32 v40, s33
    ds_write_b64 v36, v[40:41] offset:16
    s_waitcnt vmcnt(5)
    s_sub_u32 s33, s56, 1
    s_max_i32 s33, s33, s67
    v_mov_b32 v40, s33
    ds_write_b64 v36, v[40:41] offset:16
    s_waitcnt vmcnt(1)
    s_sub_u32 s33, s56, 0
    s_max_i32 s33, s33, s67
    v_mov_b32 v40, s33
    ds_write_b64 v36, v[40:41] offset:16
    s_endpgm
L_consumer:
    s_barrier
    s_and_b32 s62, s54, 1
    s_lshr_b32 s33, s54, 1
    s_or_b32 s62, s62, s33
    s_lshl_b32 s56, s62, 1
    s_add_u32 s56, s56, 2
    s_mov_b32 s57, 0
    s_lshl_b32 s58, s62, 13
    s_mov_b32 s63, 0
    s_mov_b32 s64, 2
    s_mov_b32 s65, 0
    v_and_b32 v12, 1, v0
    v_bfe_u32 v13, v0, 1, 2
    v_mov_b32 v14, 0x0c0c0100
    v_mov_b32 v15, 0x01000c0c
    v_cmp_eq_u32 vcc, 1, v12
    v_mov_b32 v16, 0x0c0c0302
    v_mov_b32 v17, 0x03020c0c
    v_cndmask_b32 v14, v14, v15, vcc
    v_cndmask_b32 v16, v16, v17, vcc
    v_mov_b32 v15, 0x0c0c0c0c
    v_cmp_eq_u32 vcc, 0, v13
    s_nop 1
    v_cndmask_b32 v4, v15, v14, vcc
    v_cndmask_b32 v8, v15, v16, vcc
    v_cmp_eq_u32 vcc, 1, v13
    s_nop 1
    v_cndmask_b32 v5, v15, v14, vcc
    v_cndmask_b32 v9, v15, v16, vcc
    v_cmp_eq_u32 vcc, 2, v13
    s_nop 1
    v_cndmask_b32 v6, v15, v14, vcc
    v_cndmask_b32 v10, v15, v16, vcc
    v_cmp_eq_u32 vcc, 3, v13
    s_nop 1
    v_cndmask_b32 v7, v15, v14, vcc
    v_cndmask_b32 v11, v15, v16, vcc
    v_lshlrev_b32 v12, 8, v2
    v_xor_b32 v13, v2, v1
    v_xor_b32 v14, 0, v13
    v_lshl_add_u32 v25, v14, 4, v12
    v_xor_b32 v14, 4, v13
    v_lshl_add_u32 v26, v14, 4, v12
    v_xor_b32 v14, 8, v13
    v_lshl_add_u32 v27, v14, 4, v12
    v_xor_b32 v14, 12, v13
    v_lshl_add_u32 v28, v14, 4, v12
    v_lshlrev_b32 v12, 10, v1
    v_lshl_add_u32 v29, v2, 4, v12
    v_lshrrev_b32 v13, 3, v2
    v_lshlrev_b32 v12, 8, v13
    v_lshl_add_u32 v12, v1, 4, v12
    v_add_u32 v30, 131072, v12
    v_lshl_add_u32 v12, v1, 1, v13
    v_lshlrev_b32 v12, 4, v12
    s_mul_i32 s33, s62, 3584
    s_add_u32 s33, s33, 144384
    v_add_u32 v35, s33, v12
    s_lshl_b32 s33, s62, 10
    s_add_u32 s33, s33, 132096
    v_lshlrev_b32 v12, 4, v0
    v_add_u32 v31, s33, v12
    s_lshl_b32 s33, s62, 9
    s_add_u32 s33, s33, 140288
    v_lshlrev_b32 v12, 3, v0
    v_add_u32 v32, s33, v12
    v_mov_b32 v33, 158720
    s_lshl_b32 s33, s62, 2
    s_add_u32 s33, s33, 158752
    v_mov_b32 v34, s33
    s_mov_b32 s55, 0x3e0293ee
    v_mov_b32 v20, 0xff800000
    v_mov_b32 v39, 0
    v_mov_b32 v60, 0
    v_mov_b32 v61, 0
    v_mov_b32 v62, 0
    v_mov_b32 v63, 0
L_cwait0:
    s_mov_b32 s61, 0
L_cwait:
    ds_read_b64 v[36:37], v33 offset:16
    s_add_u32 s61, s61, 1
    s_cmp_ge_u32 s61, 1048576
    s_cbranch_scc1 L_end
    s_waitcnt lgkmcnt(0)
    v_readfirstlane_b32 s59, v36
    v_readfirstlane_b32 s60, v37
    s_nop 2
    s_cmp_ge_i32 s59, s56
    s_cbranch_scc1 L_go
    s_cmp_gt_u32 s56, s60
    s_cbranch_scc1 L_done
    s_branch L_cwait
L_go:
    s_cmp_eq_u32 s63, 1
    s_cbranch_scc1 L_vitem
    s_cmp_eq_u32 s63, 0
    s_cbranch_scc1 L_kitem
    v_add_u32 v40, s58, v25
    v_add_u32 v41, s58, v26
    v_add_u32 v42, s58, v27
    v_add_u32 v43, s58, v28
    v_add_u32 v44, s58, v29
    ds_read_b128 v[88:91], v40
    ds_read_b128 v[92:95], v41
    ds_read_b128 v[96:99], v42
    ds_read_b128 v[100:103], v43
    s_add_u32 s66, s56, s67
    s_add_u32 s58, s58, 32768
    s_and_b32 s58, s58, 131071
    s_add_u32 s56, s56, 8
    s_add_u32 s57, s57, 1
    v_mov_b32 v36, s57
    s_waitcnt lgkmcnt(3)
    v_mfma_f32_16x16x32_bf16 v[52:55], v[88:91], v[72:75], 0
    s_waitcnt lgkmcnt(2)
    v_mfma_f32_16x16x32_bf16 v[52:55], v[92:95], v[76:79], v[52:55]
    s_waitcnt lgkmcnt(1)
    v_mfma_f32_16x16x32_bf16 v[52:55], v[96:99], v[80:83], v[52:55]
    s_waitcnt lgkmcnt(0)
    v_mfma_f32_16x16x32_bf16 v[52:55], v[100:103], v[84:87], v[52:55]
    ds_read_b32 v16, v33 offset:16
    s_nop 6
    v_max3_f32 v12, v52, v53, v54
    v_max_f32 v12, v12, v55
    v_mov_b32 v3, v12
    s_nop 1
    v_permlane32_swap_b32 v12, v3
    v_max_f32 v12, v12, v3
    v_mov_b32 v3, v12
    s_nop 1
    v_permlane16_swap_b32 v12, v3
    v_max_f32 v12, v12, v3
    s_waitcnt lgkmcnt(0)
    v_readfirstlane_b32 s59, v16
    v_mul_f32 v12, s55, v12
    v_max_f32 v47, v38, v12
    v_sub_f32 v46, v38, v47
    s_cmp_ge_i32 s59, s66
    s_cselect_b32 s35, 1, 0
    s_cbranch_scc0 L_nov
    ds_read_b128 v[120:123], v44 offset:8192
    ds_read_b128 v[124:127], v44 offset:8448
    ds_read_b128 v[128:131], v44 offset:8704
    ds_read_b128 v[132:135], v44 offset:8960
L_nov:
    v_fma_f32 v64, v52, s55, -v47
    v_fma_f32 v65, v53, s55, -v47
    v_fma_f32 v66, v54, s55, -v47
    v_fma_f32 v67, v55, s55, -v47
    v_exp_f32 v46, v46
    v_exp_f32 v64, v64
    v_exp_f32 v65, v65
    v_exp_f32 v66, v66
    v_exp_f32 v67, v67
    v_mov_b32 v38, v47
    v_cvt_pk_bf16_f32 v48, v64, v65
    v_cvt_pk_bf16_f32 v49, v66, v67
    v_mul_f32 v60, v46, v60
    v_mul_f32 v61, v46, v61
    v_mul_f32 v62, v46, v62
    v_mul_f32 v63, v46, v63
    v_perm_b32 v152, v48, v48, v4
    v_perm_b32 v153, v48, v48, v5
    v_perm_b32 v154, v48, v48, v6
    v_perm_b32 v155, v48, v48, v7
    v_perm_b32 v156, v48, v48, v8
    v_perm_b32 v157, v48, v48, v9
    v_perm_b32 v158, v48, v48, v10
    v_perm_b32 v159, v48, v48, v11
    v_perm_b32 v160, v49, v49, v4
    v_perm_b32 v161, v49, v49, v5
    v_perm_b32 v162, v49, v49, v6
    v_perm_b32 v163, v49, v49, v7
    v_perm_b32 v164, v49, v49, v8
    v_perm_b32 v165, v49, v49, v9
    v_perm_b32 v166, v49, v49, v10
    v_perm_b32 v167, v49, v49, v11
    v_fma_f32 v39, v39, v46, v64
    v_add_f32 v65, v65, v66
    v_add_f32 v39, v39, v67
    v_add_f32 v39, v39, v65
    s_cmp_eq_u32 s35, 1
    s_cbranch_scc1 L_vok
    s_mov_b32 s61, 0
L_vw:
    ds_read_b32 v16, v33 offset:16
    s_add_u32 s61, s61, 1
    s_cmp_ge_u32 s61, 1048576
    s_cbranch_scc1 L_end
    s_waitcnt lgkmcnt(0)
    v_readfirstlane_b32 s59, v16
    s_nop 3
    s_cmp_ge_i32 s59, s66
    s_cbranch_scc0 L_vw
    ds_read_b128 v[120:123], v44 offset:8192
    ds_read_b128 v[124:127], v44 offset:8448
    ds_read_b128 v[128:131], v44 offset:8704
    ds_read_b128 v[132:135], v44 offset:8960
L_vok:
    s_waitcnt lgkmcnt(3)
    v_mfma_f32_16x16x32_bf16 v[60:63], v[120:123], v[152:155], v[60:63]
    s_waitcnt lgkmcnt(2)
    v_mfma_f32_16x16x32_bf16 v[60:63], v[124:127], v[156:159], v[60:63]
    s_waitcnt lgkmcnt(1)
    v_mfma_f32_16x16x32_bf16 v[60:63], v[128:131], v[160:163], v[60:63]
    s_waitcnt lgkmcnt(0)
    v_mfma_f32_16x16x32_bf16 v[60:63], v[132:135], v[164:167], v[60:63]
    ds_write_b32 v34, v36
L_next:
    s_cmp_ge_i32 s59, s56
    s_cbranch_scc1 L_go
    s_branch L_cwait0
L_kitem:
    v_add_u32 v40, s58, v25
    v_add_u32 v41, s58, v26
    v_add_u32 v42, s58, v27
    v_add_u32 v43, s58, v28
    v_add_u32 v45, s65, v35
    ds_read_b128 v[88:91], v40 offset:0
    ds_read_b128 v[92:95], v41 offset:0
    ds_read_b128 v[96:99], v42 offset:0
    ds_read_b128 v[100:103], v43 offset:0
    ds_read_b128 v[104:107], v40 offset:4096
    ds_read_b128 v[108:111], v41 offset:4096
    ds_read_b128 v[112:115], v42 offset:4096
    ds_read_b128 v[116:119], v43 offset:4096
    s_add_u32 s58, s58, 32768
    s_and_b32 s58, s58, 131071
    s_add_u32 s56, s56, 8
    s_add_u32 s57, s57, 1
    v_mov_b32 v36, s57
    s_add_u32 s65, s65, 256
    s_cmp_eq_u32 s57, 1
    s_cbranch_scc1 L_first
L_kgo:
    s_waitcnt lgkmcnt(7)
    v_mfma_f32_16x16x32_bf16 v[52:55], v[88:91], v[72:75], 0
    s_waitcnt lgkmcnt(6)
    v_mfma_f32_16x16x32_bf16 v[52:55], v[92:95], v[76:79], v[52:55]
    s_waitcnt lgkmcnt(5)
    v_mfma_f32_16x16x32_bf16 v[52:55], v[96:99], v[80:83], v[52:55]
    s_waitcnt lgkmcnt(4)
    v_mfma_f32_16x16x32_bf16 v[52:55], v[100:103], v[84:87], v[52:55]
    s_waitcnt lgkmcnt(3)
    v_mfma_f32_16x16x32_bf16 v[56:59], v[104:107], v[72:75], 0
    s_waitcnt lgkmcnt(2)
    v_mfma_f32_16x16x32_bf16 v[56:59], v[108:111], v[76:79], v[56:59]
    s_waitcnt lgkmcnt(1)
    v_mfma_f32_16x16x32_bf16 v[56:59], v[112:115], v[80:83], v[56:59]
    s_waitcnt lgkmcnt(0)
    v_mfma_f32_16x16x32_bf16 v[56:59], v[116:119], v[84:87], v[56:59]
    ds_write_b32 v34, v36
    s_nop 2
    ds_write_b128 v45, v[52:55]
    v_max3_f32 v20, v20, v52, v53
    v_max3_f32 v20, v20, v54, v55
    s_nop 2
    ds_write_b128 v45, v[56:59] offset:128
    v_max3_f32 v20, v20, v56, v57
    v_max3_f32 v20, v20, v58, v59
    s_cmp_eq_u32 s57, s64
    s_cbranch_scc0 L_next
    v_mov_b32 v3, v20
    s_nop 1
    v_permlane32_swap_b32 v20, v3
    v_max_f32 v20, v20, v3
    v_mov_b32 v3, v20
    s_nop 1
    v_permlane16_swap_b32 v20, v3
    v_max_f32 v20, v20, v3
    v_mul_f32 v38, s55, v20
    s_mov_b32 s63, 1
    s_mov_b32 s65, 0
    s_cmp_eq_u32 s57, 2
    s_cselect_b32 s64, 4, 32
    s_branch L_next
L_vitem:
    v_add_u32 v45, s65, v35
    v_add_u32 v44, s58, v29
    ds_read_b128 v[52:55], v45
    ds_read_b128 v[56:59], v45 offset:128
    ds_read_b128 v[120:123], v44 offset:0
    ds_read_b128 v[124:127], v44 offset:256
    ds_read_b128 v[128:131], v44 offset:512
    ds_read_b128 v[132:135], v44 offset:768
    ds_read_b128 v[136:139], v44 offset:4096
    ds_read_b128 v[140:143], v44 offset:4352
    ds_read_b128 v[144:147], v44 offset:4608
    ds_read_b128 v[148:151], v44 offset:4864
    s_add_u32 s58, s58, 32768
    s_and_b32 s58, s58, 131071
    s_add_u32 s56, s56, 8
    s_add_u32 s57, s57, 1
    v_mov_b32 v36, s57
    s_add_u32 s65, s65, 256
    s_waitcnt lgkmcnt(8)
    v_fma_f32 v64, v52, s55, -v38
    v_fma_f32 v65, v53, s55, -v38
    v_fma_f32 v66, v54, s55, -v38
    v_fma_f32 v67, v55, s55, -v38
    v_fma_f32 v68, v56, s55, -v38
    v_fma_f32 v69, v57, s55, -v38
    v_fma_f32 v70, v58, s55, -v38
    v_fma_f32 v71, v59, s55, -v38
    v_exp_f32 v64, v64
    v_exp_f32 v65, v65
    v_exp_f32 v66, v66
    v_exp_f32 v67, v67
    v_exp_f32 v68, v68
    v_exp_f32 v69, v69
    v_exp_f32 v70, v70
    v_exp_f32 v71, v71
    s_nop 0
    v_cvt_pk_bf16_f32 v48, v64, v65
    v_cvt_pk_bf16_f32 v49, v66, v67
    v_cvt_pk_bf16_f32 v50, v68, v69
    v_cvt_pk_bf16_f32 v51, v70, v71
    v_perm_b32 v152, v48, v48, v4
    v_perm_b32 v153, v48, v48, v5
    v_perm_b32 v154, v48, v48, v6
    v_perm_b32 v155, v48, v48, v7
    s_waitcnt lgkmcnt(0)
    ds_write_b32 v34, v36
    v_perm_b32 v156, v48, v48, v8
    v_perm_b32 v157, v48, v48, v9
    v_perm_b32 v158, v48, v48, v10
    v_perm_b32 v159, v48, v48, v11
    v_mfma_f32_16x16x32_bf16 v[60:63], v[120:123], v[152:155], v[60:63]
    v_perm_b32 v160, v49, v49, v4
    v_perm_b32 v161, v49, v49, v5
    v_perm_b32 v162, v49, v49, v6
    v_perm_b32 v163, v49, v49, v7
    v_mfma_f32_16x16x32_bf16 v[60:63], v[124:127], v[156:159], v[60:63]
    v_perm_b32 v164, v49, v49, v8
    v_perm_b32 v165, v49, v49, v9
    v_perm_b32 v166, v49, v49, v10
    v_perm_b32 v167, v49, v49, v11
    v_mfma_f32_16x16x32_bf16 v[60:63], v[128:131], v[160:163], v[60:63]
    v_perm_b32 v168, v50, v50, v4
    v_perm_b32 v169, v50, v50, v5
    v_perm_b32 v170, v50, v50, v6
    v_perm_b32 v171, v50, v50, v7
    v_mfma_f32_16x16x32_bf16 v[60:63], v[132:135], v[164:167], v[60:63]
    v_perm_b32 v172, v50, v50, v8
    v_perm_b32 v173, v50, v50, v9
    v_perm_b32 v174, v50, v50, v10
    v_perm_b32 v175, v50, v50, v11
    v_mfma_f32_16x16x32_bf16 v[60:63], v[136:139], v[168:171], v[60:63]
    v_perm_b32 v176, v51, v51, v4
    v_perm_b32 v177, v51, v51, v5
    v_perm_b32 v178, v51, v51, v6
    v_perm_b32 v179, v51, v51, v7
    v_mfma_f32_16x16x32_bf16 v[60:63], v[140:143], v[172:175], v[60:63]
    v_perm_b32 v180, v51, v51, v8
    v_perm_b32 v181, v51, v51, v9
    v_perm_b32 v182, v51, v51, v10
    v_perm_b32 v183, v51, v51, v11
    v_mfma_f32_16x16x32_bf16 v[60:63], v[144:147], v[176:179], v[60:63]
    v_add_f32 v64, v64, v65
    v_add_f32 v66, v66, v67
    v_mfma_f32_16x16x32_bf16 v[60:63], v[148:151], v[180:183], v[60:63]
    v_add_f32 v68, v68, v69
    v_add_f32 v70, v70, v71
    v_add_f32 v64, v64, v66
    v_add_f32 v68, v68, v70
    v_add_f32 v39, v39, v64
    v_add_f32 v39, v39, v68
    s_cmp_eq_u32 s57, s64
    s_cbranch_scc0 L_next
    s_cmp_eq_u32 s57, 4
    s_cbranch_scc1 L_switch
    s_mov_b32 s63, 2
    s_and_b32 s33, s62, 1
    s_lshl_b32 s34, s33, 12
    s_sub_u32 s58, s58, s34
    s_add_u32 s67, s33, 1
    s_lshl_b32 s33, s33, 1
    s_sub_u32 s56, s56, s33
    s_branch L_next
L_first:
    s_waitcnt lgkmcnt(0)
    ds_write_b32 v34, v36
    s_mov_b32 s61, 0
L_qwait:
    ds_read_b32 v12, v33
    s_add_u32 s61, s61, 1
    s_cmp_ge_u32 s61, 1048576
    s_cbranch_scc1 L_end
    s_waitcnt lgkmcnt(0)
    v_readfirstlane_b32 s33, v12
    s_sleep 1
    s_cmp_eq_u32 s33, 0
    s_cbranch_scc1 L_qwait
    ds_read_b128 v[72:75], v30 offset:0
    ds_read_b128 v[76:79], v30 offset:64
    ds_read_b128 v[80:83], v30 offset:128
    ds_read_b128 v[84:87], v30 offset:192
    s_waitcnt lgkmcnt(0)
    s_branch L_kgo
L_switch:
    s_nop 7
    ds_write_b128 v31, v[60:63] offset:0
    ds_write_b64 v32, v[38:39] offset:0
    v_mov_b32 v12, 1
    s_waitcnt lgkmcnt(0)
    s_mov_b64 exec, 1
    ds_add_u32 v33, v12 offset:4
    s_mov_b64 exec, -1
    ds_read_b128 v[72:75], v30 offset:512
    ds_read_b128 v[76:79], v30 offset:576
    ds_read_b128 v[80:83], v30 offset:640
    ds_read_b128 v[84:87], v30 offset:704
    v_mov_b32 v20, 0xff800000
    v_mov_b32 v39, 0
    v_mov_b32 v60, 0
    v_mov_b32 v61, 0
    v_mov_b32 v62, 0
    v_mov_b32 v63, 0
    s_mov_b32 s63, 0
    s_mov_b32 s65, 0
    s_mov_b32 s64, 18
    s_waitcnt lgkmcnt(0)
    s_branch L_next
L_done:
    s_nop 7
    ds_write_b128 v31, v[60:63] offset:4096
    ds_write_b64 v32, v[38:39] offset:2048
    v_mov_b32 v12, 1
    s_waitcnt lgkmcnt(0)
    s_mov_b64 exec, 1
    ds_add_u32 v33, v12 offset:8
    s_mov_b64 exec, -1
    s_endpgm
L_codeend:
.section .rodata,"a"
.p2align 6
.amdhsa_kernel concat_heads__sliding_block_cached__gqa_block_cached__decode_kernel
  .amdhsa_next_free_vgpr 240
  .amdhsa_next_free_sgpr 96
  .amdhsa_accum_offset 240
  .amdhsa_group_segment_fixed_size 0
  .amdhsa_kernarg_size 104
  .amdhsa_user_sgpr_count 2
  .amdhsa_user_sgpr_kernarg_segment_ptr 1
  .amdhsa_system_sgpr_workgroup_id_x 1
  .amdhsa_float_denorm_mode_32 3
.end_amdhsa_kernel
```
